```python
import torch

def _softmax(x, axis=-1):
    return torch.softmax(x, dim=axis)
def _gelu(x):
    return torch.nn.functional.gelu(x, approximate="tanh")
def _silu(x):
    return torch.nn.functional.silu(x)
def _sigmoid(x):
    return torch.sigmoid(x)
def _layernorm(x, axis=-1, eps=1e-5):
    m = x.mean(dim=axis, keepdim=True)
    v = x.var(dim=axis, keepdim=True, unbiased=False)
    return (x - m) / torch.sqrt(v + eps)
def _scatter_add(tgt, idx, src, axis=0):
    return tgt.clone().index_add_(axis, idx, src)
def _segment_sum(src, seg, n):
    out = torch.zeros((n,) + src.shape[1:], dtype=src.dtype)
    return out.index_add_(0, seg, src)
def _pad(x, pw):
    flat = tuple(v for pair in reversed(pw) for v in pair)
    return torch.nn.functional.pad(x, flat)

kernel_name = 'gated_mix__ssm_conv_s5__glu_gated_glu__prompt'

def setup_inputs():

    _w = (lambda a: (lambda t: t.to(torch.bfloat16) if t.is_floating_point() else t)(torch.as_tensor(a)))
    def _A_setup():
        B, S, D = 1, 2048, 448
        P = D
        Lambda_re = -0.5 * (lambda _x: torch.exp(torch.as_tensor(_x)))((lambda *s: torch.randn(*s, dtype=torch.bfloat16) * 0.4)(P))
        Lambda_im = (lambda *s: torch.randn(*s, dtype=torch.bfloat16) * 0.8)(P) * 1.0
        B_re = (lambda *s: torch.randn(*s, dtype=torch.bfloat16) * 0.8)(P, D) * (D ** -0.5)
        B_im = (lambda *s: torch.randn(*s, dtype=torch.bfloat16) * 0.8)(P, D) * (D ** -0.5)
        C_re = (lambda *s: torch.randn(*s, dtype=torch.bfloat16) * 0.8)(D, P) * (P ** -0.5)
        C_im = (lambda *s: torch.randn(*s, dtype=torch.bfloat16) * 0.8)(D, P) * (P ** -0.5)
        log_dt = (lambda *s: torch.randn(*s, dtype=torch.bfloat16) * 0.4)(P) * 0.3 - 2.0
        Dskip = (lambda *s: torch.randn(*s, dtype=torch.bfloat16) * 0.1)(D)
        return {
            "x": _w((lambda *s: torch.randn(*s, dtype=torch.bfloat16) * 0.05)(B, S, D)),
            "Lambda_re": _w(Lambda_re),
            "Lambda_im": _w(Lambda_im),
            "B_re": _w(B_re),
            "B_im": _w(B_im),
            "C_re": _w(C_re),
            "C_im": _w(C_im),
            "log_dt": _w(log_dt),
            "Dskip": _w(Dskip),
        }
    _A_in = _A_setup()

    def _B_setup():
        B, S, D, F = 1, 2048, 448, 1792
        return {
            "x": _w((lambda *s: torch.randn(*s, dtype=torch.bfloat16) * 0.05)(B, S, D)),
            "w_gate": _w((lambda *s: torch.randn(*s, dtype=torch.bfloat16) * 0.4)(D, F)),
            "w_up": _w((lambda *s: torch.randn(*s, dtype=torch.bfloat16) * 0.05)(D, F)),
            "w_down": _w((lambda *s: torch.randn(*s, dtype=torch.bfloat16) * 0.05)(F, D)),
        }
    _B_in = _B_setup()

    return {
        "A_x": _A_in["x"],
        "A_Lambda_re": _A_in["Lambda_re"],
        "A_Lambda_im": _A_in["Lambda_im"],
        "A_B_re": _A_in["B_re"],
        "A_B_im": _A_in["B_im"],
        "A_C_re": _A_in["C_re"],
        "A_C_im": _A_in["C_im"],
        "A_log_dt": _A_in["log_dt"],
        "A_Dskip": _A_in["Dskip"],
        "B_x": _B_in["x"],
        "B_w_gate": _B_in["w_gate"],
        "B_w_up": _B_in["w_up"],
        "B_w_down": _B_in["w_down"],
        "gate_w": _w((lambda *s: torch.randn(*s, dtype=torch.bfloat16) * 0.05)(448) * 16.0),
    }

def reference(A_x, A_Lambda_re, A_Lambda_im, A_B_re, A_B_im, A_C_re, A_C_im, A_log_dt, A_Dskip, B_x, B_w_gate, B_w_up, B_w_down, gate_w):
    def _A_ref(x, Lambda_re, Lambda_im, B_re, B_im, C_re, C_im, log_dt, Dskip):
        Bsz, L, H = x.shape
        Lam = Lambda_re + 1j * Lambda_im
        Bmat = B_re + 1j * B_im
        Cmat = C_re + 1j * C_im
        dt = torch.exp(log_dt)
        Lam_bar = torch.exp(dt * Lam)
        B_bar = ((Lam_bar - 1.0) / Lam)[:, None] * Bmat
        Bu = torch.einsum("bld,pd->blp", x + 0j, B_bar)
        h = torch.zeros_like(Bu[:, 0, :])
        hs = []
        for t in range(L):
            h = Lam_bar[None, :] * h + Bu[:, t, :]
            hs.append(h)
        hseq = torch.stack(hs, 1)
        y = 2.0 * torch.einsum("blp,dp->bld", hseq, Cmat).real + x * Dskip[None, None, :]
        return y

    def _B_ref(x, w_gate, w_up, w_down):
        g = torch.einsum("bsd,df->bsf", x, w_gate)
        u = torch.einsum("bsd,df->bsf", x, w_up)
        h = _sigmoid(g) * u
        return torch.einsum("bsf,fd->bsd", h, w_down)

    x = A_x
    g = _sigmoid((x * gate_w).sum(-1, keepdims=True))
    a = _A_ref(x, A_Lambda_re, A_Lambda_im, A_B_re, A_B_im, A_C_re, A_C_im, A_log_dt, A_Dskip)
    b = _B_ref(x, B_w_gate, B_w_up, B_w_down)
    return g * a + (1 - g) * b
```

```asm
; @launch grid=(256,1,1) block=(256,1,1) lds=163840
.amdgcn_target "amdgcn-amd-amdhsa--gfx950"
.text
.globl gated_mix__ssm_conv_s5__glu_gated_glu__prompt_kernel
.p2align 8
.type gated_mix__ssm_conv_s5__glu_gated_glu__prompt_kernel,@function
gated_mix__ssm_conv_s5__glu_gated_glu__prompt_kernel:
    s_cmp_ge_u32 s2, 0x100
    s_cbranch_scc1 L_END
    s_load_dwordx2 s[44:45], s[0:1], 0
    s_load_dwordx2 s[48:49], s[0:1], 80
    s_load_dwordx2 s[52:53], s[0:1], 88
    s_load_dwordx2 s[72:73], s[0:1], 128
    s_load_dwordx4 s[8:11], s[0:1], 8
    s_load_dwordx4 s[16:19], s[0:1], 56
    s_cmp_lt_u32 s2, 224
    s_cbranch_scc1 L_NOPF
    s_getpc_b64 s[4:5]
L_PC:
    v_lshlrev_b32 v254, 7, v0
    v_min_u32 v254, L_CODE_END-L_PC-4, v254
    global_load_dword v254, v254, s[4:5]
L_NOPF:
    v_lshrrev_b32 v224, 6, v0
    v_and_b32 v1, 63, v0
    v_readfirstlane_b32 s43, v224
    s_and_b32 s3, s2, 7
    s_lshr_b32 s6, s2, 3
    s_mov_b32 s96, 65536
    s_mul_i32 s7, s6, 37
    s_lshr_b32 s7, s7, 8
    s_and_b32 s83, s3, 1
    s_lshr_b32 s3, s3, 1
    s_lshl_b32 s3, s3, 2
    s_cmp_ge_u32 s6, 28
    s_cbranch_scc1 L_HELPER
    s_add_u32 s80, s3, s7
    s_mul_i32 s4, s7, 2
    s_mul_i32 s7, s7, 7
    s_sub_u32 s82, s6, s7
    s_mul_i32 s7, s83, 7
    s_add_u32 s81, s7, s82
    s_mul_i32 s5, s82, 0
    s_add_u32 s4, s4, s5
    s_mul_i32 s5, s4, 37
    s_lshr_b32 s5, s5, 8
    s_mul_i32 s5, s5, 7
    s_sub_u32 s4, s4, s5
    s_lshl_b32 s22, s4, 7
    s_mul_i32 s29, s4, 229376
    s_lshl_b32 s84, s43, 12
    s_lshl_b32 s85, s43, 11
    v_lshrrev_b32 v225, 3, v1
    v_and_b32 v226, 7, v1
    v_lshrrev_b32 v227, 1, v225
    s_lshl_b32 s3, s80, 2
    s_add_u32 s97, s3, s43
    s_mul_i32 s3, s97, 28672
    v_and_b32 v232, 3, v225
    v_lshrrev_b32 v233, 2, v225
    v_lshl_add_u32 v232, v233, 4, v232
    v_mul_u32_u24 v232, 896, v232
    v_xor_b32 v251, v226, v227
    v_lshl_add_u32 v2, v251, 4, v232
    v_add_u32 v2, s3, v2
    v_xor_b32 v3, 64, v2
    s_mul_i32 s3, s43, 57344
    s_lshl_b32 s7, s81, 8
    s_add_u32 s3, s3, s7
    v_and_b32 v252, 1, v227
    v_lshlrev_b32 v232, 1, v252
    v_xor_b32 v232, v226, v232
    v_mul_u32_u24 v233, 3584, v225
    v_lshl_add_u32 v4, v232, 4, v233
    v_add_u32 v4, s3, v4
    v_xor_b32 v5, 64, v4
    s_movk_i32 s86, 2560
    s_movk_i32 s87, 5120
    s_movk_i32 s88, 7680
    s_mov_b32 s46, 1835008
    s_mov_b32 s47, 0x20000
    s_mov_b32 s50, 1605632
    s_mov_b32 s51, 0x20000
    s_mov_b32 s54, 1607680
    s_mov_b32 s55, 0x20000
    s_mov_b32 s74, 15597568
    s_mov_b32 s75, 0x20000
    s_waitcnt lgkmcnt(0)
    s_sub_u32 s52, s52, 2048
    s_subb_u32 s53, s53, 0
    s_load_dwordx2 s[56:57], s[0:1], 24
    s_load_dwordx2 s[60:61], s[0:1], 32
    s_load_dwordx2 s[64:65], s[0:1], 96
    s_load_dwordx2 s[76:77], s[0:1], 112
    s_load_dwordx2 s[68:69], s[0:1], 40
    s_load_dwordx2 s[12:13], s[0:1], 48
    s_add_u32 m0, s84, 16384
    v_add_u32 v62, s22, v2
    v_add_u32 v61, s22, v3
    buffer_load_dwordx4 v62, s[44:47], 0 offen offset:0 lds
    buffer_load_dwordx4 v61, s[44:47], s86 offen offset:1024 lds
    buffer_load_dwordx4 v62, s[44:47], s87 offen offset:2048 lds
    buffer_load_dwordx4 v61, s[44:47], s88 offen offset:3072 lds
    s_add_u32 m0, s84, 32768
    s_add_u32 s93, s29, 27648
    buffer_load_dwordx4 v4, s[48:51], s29 offen offset:0 lds
    buffer_load_dwordx4 v4, s[48:51], s93 offen offset:1024 lds
    buffer_load_dwordx4 v5, s[52:55], s29 offen offset:2048 lds
    buffer_load_dwordx4 v5, s[52:55], s93 offen offset:3072 lds
    s_add_u32 s23, s22, 128
    s_cmp_eq_u32 s23, 896
    s_cselect_b32 s23, 0, s23
    s_mul_i32 s30, s23, 1792
    s_add_u32 s24, s23, 128
    s_cmp_eq_u32 s24, 896
    s_cselect_b32 s24, 0, s24
    s_mul_i32 s31, s24, 1792
    s_add_u32 s25, s24, 128
    s_cmp_eq_u32 s25, 896
    s_cselect_b32 s25, 0, s25
    s_mul_i32 s32, s25, 1792
    s_add_u32 s26, s25, 128
    s_cmp_eq_u32 s26, 896
    s_cselect_b32 s26, 0, s26
    s_mul_i32 s33, s26, 1792
    s_add_u32 s27, s26, 128
    s_cmp_eq_u32 s27, 896
    s_cselect_b32 s27, 0, s27
    s_mul_i32 s34, s27, 1792
    s_add_u32 s28, s27, 128
    s_cmp_eq_u32 s28, 896
    s_cselect_b32 s28, 0, s28
    s_mul_i32 s35, s28, 1792
    v_and_b32 v234, 31, v1
    v_lshrrev_b32 v235, 5, v1
    s_and_b32 s6, s43, 1
    s_lshr_b32 s7, s43, 1
    v_lshrrev_b32 v236, 3, v234
    v_and_b32 v237, 7, v234
    v_lshlrev_b32 v237, 7, v237
    v_bfe_u32 v238, v234, 1, 3
    v_lshl_add_u32 v239, v236, 10, v237
    v_lshl_add_u32 v240, v236, 11, v237
    s_xor_b32 s4, s84, 0x1000
    v_xor_b32 v238, v238, v235
    v_xor_b32 v241, 0, v238
    v_lshl_add_u32 v242, v241, 4, v239
    v_lshl_add_u32 v18, v241, 4, v240
    v_add_u32 v14, s84, v242
    v_add_u32 v228, s4, v242
    v_mov_b32 v22, v242
    v_xor_b32 v241, 2, v238
    v_lshl_add_u32 v242, v241, 4, v239
    v_lshl_add_u32 v19, v241, 4, v240
    v_add_u32 v15, s84, v242
    v_add_u32 v229, s4, v242
    v_mov_b32 v23, v242
    v_xor_b32 v241, 4, v238
    v_lshl_add_u32 v242, v241, 4, v239
    v_lshl_add_u32 v20, v241, 4, v240
    v_add_u32 v16, s84, v242
    v_add_u32 v230, s4, v242
    v_mov_b32 v24, v242
    v_xor_b32 v241, 6, v238
    v_lshl_add_u32 v242, v241, 4, v239
    v_lshl_add_u32 v21, v241, 4, v240
    v_add_u32 v17, s84, v242
    v_add_u32 v231, s4, v242
    v_mov_b32 v25, v242
    v_lshrrev_b32 v236, 4, v1
    v_bfe_u32 v237, v1, 2, 2
    v_and_b32 v238, 3, v1
    v_and_b32 v239, 1, v236
    v_lshlrev_b32 v240, 7, v237
    v_lshl_add_u32 v240, v235, 10, v240
    v_lshrrev_b32 v241, 1, v237
    v_lshrrev_b32 v242, 1, v238
    v_and_b32 v243, 1, v238
    v_lshl_add_u32 v244, v243, 1, v242
    v_lshl_add_u32 v245, v239, 11, v240
    v_lshl_add_u32 v245, v244, 3, v245
    v_xor_b32 v246, s6, v239
    v_lshl_add_u32 v246, v246, 1, v241
    v_lshl_add_u32 v10, v246, 5, v245
    v_xor_b32 v11, 32, v10
    v_lshl_add_u32 v245, v239, 5, v240
    v_lshl_add_u32 v245, v238, 3, v245
    v_xor_b32 v246, s83, v241
    v_lshl_add_u32 v27, v246, 6, v245
    v_xor_b32 v26, 64, v27
    s_lshl_b32 s3, s81, 6
    v_lshl_add_u32 v253, v234, 1, s3
    global_load_ushort v248, v253, s[8:9]
    global_load_ushort v249, v253, s[10:11]
    global_load_ushort v250, v253, s[16:17]
    v_bfe_u32 v245, v234, 1, 2
    v_lshlrev_b32 v57, 1, v235
    v_xor_b32 v245, v245, v57
    v_lshlrev_b32 v57, 6, v234
    v_lshl_add_u32 v57, v245, 4, v57
    v_add_u32 v57, s85, v57
    v_lshl_add_u32 v245, v239, 1, v242
    v_lshl_add_u32 v245, v243, 2, v245
    v_lshlrev_b32 v244, 1, v241
    v_xor_b32 v245, v245, v244
    v_lshlrev_b32 v245, 3, v245
    v_lshl_add_u32 v245, v237, 6, v245
    v_lshl_add_u32 v245, v235, 9, v245
    v_add_u32 v58, s85, v245
    s_lshl_b32 s3, s43, 1
    v_add_u32 v54, s3, v235
    v_lshlrev_b32 v56, 3, v234
    v_lshl_add_u32 v55, v54, 8, v56
    v_lshlrev_b32 v245, 4, v1
    s_mul_i32 s3, s97, 172032
    s_add_u32 s3, s3, 917504
    s_lshl_b32 s4, s81, 11
    s_add_u32 s4, s4, s3
    s_add_u32 s4, s4, 114688
    v_add_u32 v29, s4, v245
    s_mul_i32 s36, s6, 172032
    s_sub_u32 s37, 172032, s36
    s_sub_u32 s3, s3, s36
    s_lshl_b32 s4, s81, 2
    s_add_u32 s4, s4, s6
    s_lshl_b32 s4, s4, 11
    s_add_u32 s4, s4, s3
    v_add_u32 v28, s4, v245
    s_lshl_b32 s3, s80, 1
    s_add_u32 s39, s3, s83
    s_add_u32 s40, s3, s7
    s_mul_i32 s3, s97, 172032
    s_add_u32 s3, s3, 917504
    s_mul_i32 s4, s83, 57344
    s_add_u32 s4, s4, s3
    v_add_u32 v30, s4, v245
    s_add_u32 s4, s3, 114688
    v_add_u32 v31, s4, v245
    s_mul_i32 s3, s40, 28
    s_lshl_b32 s4, s81, 1
    s_add_u32 s4, s4, s6
    s_add_u32 s3, s3, s4
    s_lshl_b32 s3, s3, 9
    s_add_u32 s3, s3, 425984
    v_mov_b32 v246, 0x40000000
    v_lshl_add_u32 v247, v1, 2, s3
    v_cmp_gt_u32 vcc, 32, v1
    s_mul_i32 s3, s40, 14336
    s_mul_i32 s4, s83, 7168
    s_add_u32 s3, s3, s4
    s_add_u32 s3, s3, 425984
    v_cndmask_b32 v32, v246, v247, vcc
    v_min_u32 v33, 13, v1
    v_lshl_add_u32 v33, v33, 9, s3
    v_and_b32 v236, 3, v234
    v_lshrrev_b32 v237, 3, v234
    v_lshl_add_u32 v236, v237, 2, v236
    v_bfe_u32 v237, v234, 2, 1
    v_lshl_add_u32 v236, v237, 4, v236
    s_lshl_b32 s3, s97, 8
    s_add_u32 s3, s3, 4096
    v_lshl_add_u32 v39, v236, 3, s3
    s_movk_i32 s89, 6144
    s_movk_i32 s38, 28672
    s_mov_b32 s92, 0xbfb8aa3b
    s_lshl_b32 s3, s81, 2
    s_add_u32 s3, s3, s43
    s_mul_i32 s3, s3, 7168
    s_lshl_b32 s4, s6, 6
    v_mul_u32_u24 v237, 896, v225
    v_lshl_add_u32 v238, v251, 4, v237
    v_xor_b32 v6, s4, v238
    v_add_u32 v6, s3, v6
    s_xor_b32 s4, s83, 1
    s_lshl_b32 s4, s4, 1
    s_xor_b32 s4, s4, s43
    s_lshl_b32 s3, s82, 2
    s_add_u32 s3, s3, s4
    s_mul_i32 s3, s3, 14336
    v_add_u32 v8, s3, v238
    v_xor_b32 v9, 64, v8
    v_add_u32 v9, 6144, v9
    s_mul_i32 s3, s83, 56
    s_add_u32 s3, s3, s43
    s_mul_i32 s3, s3, 14336
    s_lshl_b32 s4, s82, 7
    s_add_u32 s3, s3, s4
    v_lshlrev_b32 v239, 2, v252
    v_xor_b32 v239, v226, v239
    v_lshl_add_u32 v7, v239, 4, v237
    v_add_u32 v7, s3, v7
    s_mov_b32 s58, 401408
    s_mov_b32 s59, 0x20000
    s_mov_b32 s62, 402432
    s_mov_b32 s63, 0x20000
    s_mov_b32 s66, 1605632
    s_mov_b32 s67, 0x20000
    s_mov_b32 s78, 3670016
    s_mov_b32 s79, 0x20000
    s_mov_b32 s70, 401408
    s_mov_b32 s71, 0x20000
    s_mov_b32 s14, 401408
    s_mov_b32 s15, 0x20000
    s_lshl_b32 s3, s81, 4
    s_add_u32 s3, s3, s80
    s_lshl_b32 s3, s3, 9
    s_add_u32 s3, s3, 45056
    v_lshl_add_u32 v247, v234, 4, s3
    s_add_u32 m0, s84, 49152
    v_add_u32 v62, s23, v2
    v_add_u32 v61, s23, v3
    buffer_load_dwordx4 v62, s[44:47], 0 offen offset:0 lds
    v_cmp_eq_u32 vcc, 0, v54
    v_lshlrev_b32 v236, 1, v54
    buffer_load_dwordx4 v61, s[44:47], s86 offen offset:1024 lds
    v_lshlrev_b32 v237, 9, v236
    v_cndmask_b32 v34, v246, v247, vcc
    buffer_load_dwordx4 v62, s[44:47], s87 offen offset:2048 lds
    v_sub_u32 v247, v247, v237
    v_subrev_u32 v237, 512, v247
    buffer_load_dwordx4 v61, s[44:47], s88 offen offset:3072 lds
    v_subrev_u32 v238, 1024, v247
    v_cmp_gt_u32 vcc, s80, v236
    s_add_u32 m0, s84, 65536
    s_add_u32 s93, s30, 27648
    buffer_load_dwordx4 v4, s[48:51], s30 offen offset:0 lds
    v_add_u32 v236, 1, v236
    v_mov_b32 v59, 0
    buffer_load_dwordx4 v4, s[48:51], s93 offen offset:1024 lds
    v_cndmask_b32 v35, v246, v237, vcc
    v_cndmask_b32 v37, 0, -1, vcc
    buffer_load_dwordx4 v5, s[52:55], s30 offen offset:2048 lds
    v_cmp_gt_u32 vcc, s80, v236
    s_waitcnt lgkmcnt(0)
    s_sub_u32 s60, s60, 1024
    s_subb_u32 s61, s61, 0
    buffer_load_dwordx4 v5, s[52:55], s93 offen offset:3072 lds
    v_cndmask_b32 v36, v246, v238, vcc
    v_cndmask_b32 v38, 0, -1, vcc
    buffer_load_dword v59, v59, s[72:75], 0 offen
    s_waitcnt vmcnt(12)
    s_barrier
    ds_read_b128 a[0:3], v14 offset:16384
    ds_read_b64_tr_b16 a[224:225], v10 offset:32768
    ds_read_b64_tr_b16 a[226:227], v10 offset:33280
    ds_read_b128 a[112:115], v228 offset:16384
    ds_read_b64_tr_b16 a[228:229], v11 offset:32768
    ds_read_b64_tr_b16 a[230:231], v11 offset:33280
    s_waitcnt lgkmcnt(3)
    v_mfma_f32_32x32x16_bf16 v[64:79], a[224:227], a[0:3], 0
    ds_read_b128 a[4:7], v15 offset:16384
    ds_read_b64_tr_b16 a[232:233], v10 offset:36864
    ds_read_b64_tr_b16 a[234:235], v10 offset:37376
    s_add_u32 m0, s84, 81920
    v_add_u32 v62, s24, v2
    v_add_u32 v61, s24, v3
    buffer_load_dwordx4 v62, s[44:47], 0 offen offset:0 lds
    s_waitcnt lgkmcnt(5)
    v_mfma_f32_32x32x16_bf16 v[80:95], a[224:227], a[112:115], 0
    ds_read_b128 a[116:119], v229 offset:16384
    ds_read_b64_tr_b16 a[236:237], v11 offset:36864
    ds_read_b64_tr_b16 a[238:239], v11 offset:37376
    s_waitcnt lgkmcnt(6)
    v_mfma_f32_32x32x16_bf16 v[96:111], a[228:231], a[0:3], 0
    buffer_load_dwordx4 v61, s[44:47], s86 offen offset:1024 lds
    v_mfma_f32_32x32x16_bf16 v[112:127], a[228:231], a[112:115], 0
    buffer_load_dwordx4 v62, s[44:47], s87 offen offset:2048 lds
    s_waitcnt lgkmcnt(0)
    v_mfma_f32_32x32x16_bf16 v[64:79], a[232:235], a[4:7], v[64:79]
    ds_read_b128 a[8:11], v16 offset:16384
    ds_read_b64_tr_b16 a[224:225], v10 offset:40960
    ds_read_b64_tr_b16 a[226:227], v10 offset:41472
    buffer_load_dwordx4 v61, s[44:47], s88 offen offset:3072 lds
    v_mfma_f32_32x32x16_bf16 v[80:95], a[232:235], a[116:119], v[80:95]
    ds_read_b128 a[120:123], v230 offset:16384
    ds_read_b64_tr_b16 a[228:229], v11 offset:40960
    ds_read_b64_tr_b16 a[230:231], v11 offset:41472
    v_mfma_f32_32x32x16_bf16 v[96:111], a[236:239], a[4:7], v[96:111]
    s_add_u32 m0, s84, 98304
    s_add_u32 s93, s31, 27648
    buffer_load_dwordx4 v4, s[48:51], s31 offen offset:0 lds
    v_mfma_f32_32x32x16_bf16 v[112:127], a[236:239], a[116:119], v[112:127]
    buffer_load_dwordx4 v4, s[48:51], s93 offen offset:1024 lds
    s_waitcnt lgkmcnt(0)
    v_mfma_f32_32x32x16_bf16 v[64:79], a[224:227], a[8:11], v[64:79]
    ds_read_b128 a[12:15], v17 offset:16384
    ds_read_b64_tr_b16 a[232:233], v10 offset:45056
    ds_read_b64_tr_b16 a[234:235], v10 offset:45568
    buffer_load_dwordx4 v5, s[52:55], s31 offen offset:2048 lds
    v_mfma_f32_32x32x16_bf16 v[80:95], a[224:227], a[120:123], v[80:95]
    ds_read_b128 a[124:127], v231 offset:16384
    ds_read_b64_tr_b16 a[236:237], v11 offset:45056
    ds_read_b64_tr_b16 a[238:239], v11 offset:45568
    v_mfma_f32_32x32x16_bf16 v[96:111], a[228:231], a[8:11], v[96:111]
    buffer_load_dwordx4 v5, s[52:55], s93 offen offset:3072 lds
    v_mfma_f32_32x32x16_bf16 v[112:127], a[228:231], a[120:123], v[112:127]
    s_waitcnt lgkmcnt(0)
    v_mfma_f32_32x32x16_bf16 v[64:79], a[232:235], a[12:15], v[64:79]
    s_waitcnt vmcnt(9)
    s_barrier
    s_add_u32 m0, s84, 114688
    v_add_u32 v62, s25, v2
    v_add_u32 v61, s25, v3
    buffer_load_dwordx4 v62, s[44:47], 0 offen offset:0 lds
    v_mfma_f32_32x32x16_bf16 v[80:95], a[232:235], a[124:127], v[80:95]
    ds_read_b128 a[16:19], v14 offset:49152
    v_add_u32 v10, 0xc000, v10
    ds_read_b64_tr_b16 a[224:225], v10 offset:16384
    ds_read_b64_tr_b16 a[226:227], v10 offset:16896
    buffer_load_dwordx4 v61, s[44:47], s86 offen offset:1024 lds
    v_mfma_f32_32x32x16_bf16 v[96:111], a[236:239], a[12:15], v[96:111]
    ds_read_b128 a[128:131], v228 offset:49152
    v_add_u32 v11, 0xc000, v11
    ds_read_b64_tr_b16 a[228:229], v11 offset:16384
    ds_read_b64_tr_b16 a[230:231], v11 offset:16896
    buffer_load_dwordx4 v62, s[44:47], s87 offen offset:2048 lds
    v_mfma_f32_32x32x16_bf16 v[112:127], a[236:239], a[124:127], v[112:127]
    buffer_load_dwordx4 v61, s[44:47], s88 offen offset:3072 lds
    s_waitcnt lgkmcnt(3)
    v_mfma_f32_32x32x16_bf16 v[64:79], a[224:227], a[16:19], v[64:79]
    ds_read_b128 a[20:23], v15 offset:49152
    ds_read_b64_tr_b16 a[232:233], v10 offset:20480
    ds_read_b64_tr_b16 a[234:235], v10 offset:20992
    s_waitcnt lgkmcnt(3)
    v_mfma_f32_32x32x16_bf16 v[80:95], a[224:227], a[128:131], v[80:95]
    ds_read_b128 a[132:135], v229 offset:49152
    ds_read_b64_tr_b16 a[236:237], v11 offset:20480
    ds_read_b64_tr_b16 a[238:239], v11 offset:20992
    s_add_u32 m0, s84, 131072
    s_add_u32 s93, s32, 27648
    buffer_load_dwordx4 v4, s[48:51], s32 offen offset:0 lds
    v_mfma_f32_32x32x16_bf16 v[96:111], a[228:231], a[16:19], v[96:111]
    buffer_load_dwordx4 v4, s[48:51], s93 offen offset:1024 lds
    v_mfma_f32_32x32x16_bf16 v[112:127], a[228:231], a[128:131], v[112:127]
    buffer_load_dwordx4 v5, s[52:55], s32 offen offset:2048 lds
    s_waitcnt lgkmcnt(0)
    v_mfma_f32_32x32x16_bf16 v[64:79], a[232:235], a[20:23], v[64:79]
    ds_read_b128 a[24:27], v16 offset:49152
    ds_read_b64_tr_b16 a[224:225], v10 offset:24576
    ds_read_b64_tr_b16 a[226:227], v10 offset:25088
    buffer_load_dwordx4 v5, s[52:55], s93 offen offset:3072 lds
    v_mfma_f32_32x32x16_bf16 v[80:95], a[232:235], a[132:135], v[80:95]
    ds_read_b128 a[136:139], v230 offset:49152
    ds_read_b64_tr_b16 a[228:229], v11 offset:24576
    ds_read_b64_tr_b16 a[230:231], v11 offset:25088
    v_mfma_f32_32x32x16_bf16 v[96:111], a[236:239], a[20:23], v[96:111]
    s_add_u32 m0, s85, 147456
    v_add_u32 v62, s22, v6
    buffer_load_dwordx4 v62, s[56:59], 0 offen offset:0 lds
    v_mfma_f32_32x32x16_bf16 v[112:127], a[236:239], a[132:135], v[112:127]
    s_waitcnt lgkmcnt(0)
    v_mfma_f32_32x32x16_bf16 v[64:79], a[224:227], a[24:27], v[64:79]
    ds_read_b128 a[28:31], v17 offset:49152
    ds_read_b64_tr_b16 a[232:233], v10 offset:28672
    ds_read_b64_tr_b16 a[234:235], v10 offset:29184
    buffer_load_dwordx4 v62, s[60:63], 0 offen offset:1024 lds
    v_mfma_f32_32x32x16_bf16 v[80:95], a[224:227], a[136:139], v[80:95]
    ds_read_b128 a[140:143], v231 offset:49152
    ds_read_b64_tr_b16 a[236:237], v11 offset:28672
    ds_read_b64_tr_b16 a[238:239], v11 offset:29184
    s_add_u32 m0, s85, 155648
    v_add_u32 v62, s23, v6
    buffer_load_dwordx4 v62, s[56:59], 0 offen offset:0 lds
    v_mfma_f32_32x32x16_bf16 v[96:111], a[228:231], a[24:27], v[96:111]
    buffer_load_dwordx4 v62, s[60:63], 0 offen offset:1024 lds
    v_lshlrev_b32 v250, 16, v250
    v_lshlrev_b32 v248, 16, v248
    v_mfma_f32_32x32x16_bf16 v[112:127], a[228:231], a[136:139], v[112:127]
    v_mul_f32 v250, 0x3fb8aa3b, v250
    v_lshlrev_b32 v249, 16, v249
    v_exp_f32 v250, v250
    v_cvt_f32_u32 v253, v54
    s_waitcnt lgkmcnt(0)
    v_mfma_f32_32x32x16_bf16 v[64:79], a[232:235], a[28:31], v[64:79]
    s_waitcnt vmcnt(12)
    s_barrier
    s_add_u32 m0, s84, 16384
    v_add_u32 v62, s26, v2
    v_add_u32 v61, s26, v3
    buffer_load_dwordx4 v62, s[44:47], 0 offen offset:0 lds
    v_mfma_f32_32x32x16_bf16 v[80:95], a[232:235], a[140:143], v[80:95]
    v_add_u32 v14, 0xc000, v14
    ds_read_b128 a[32:35], v14 offset:32768
    ds_read_b64_tr_b16 a[224:225], v10 offset:49152
    ds_read_b64_tr_b16 a[226:227], v10 offset:49664
    buffer_load_dwordx4 v61, s[44:47], s86 offen offset:1024 lds
    v_cvt_pk_bf16_f32 v250, v250, v250
    v_mfma_f32_32x32x16_bf16 v[96:111], a[236:239], a[28:31], v[96:111]
    v_add_u32 v228, 0xc000, v228
    ds_read_b128 a[144:147], v228 offset:32768
    ds_read_b64_tr_b16 a[228:229], v11 offset:49152
    ds_read_b64_tr_b16 a[230:231], v11 offset:49664
    buffer_load_dwordx4 v62, s[44:47], s87 offen offset:2048 lds
    v_mfma_f32_32x32x16_bf16 v[112:127], a[236:239], a[140:143], v[112:127]
    buffer_load_dwordx4 v61, s[44:47], s88 offen offset:3072 lds
    v_and_b32 v250, 0xffff0000, v250
    s_waitcnt lgkmcnt(3)
    v_mfma_f32_32x32x16_bf16 v[64:79], a[224:227], a[32:35], v[64:79]
    v_add_u32 v15, 0xc000, v15
    ds_read_b128 a[36:39], v15 offset:32768
    ds_read_b64_tr_b16 a[232:233], v10 offset:53248
    ds_read_b64_tr_b16 a[234:235], v10 offset:53760
    v_mul_f32 v251, v250, v248
    s_waitcnt lgkmcnt(3)
    v_mfma_f32_32x32x16_bf16 v[80:95], a[224:227], a[144:147], v[80:95]
    v_add_u32 v229, 0xc000, v229
    ds_read_b128 a[148:151], v229 offset:32768
    ds_read_b64_tr_b16 a[236:237], v11 offset:53248
    ds_read_b64_tr_b16 a[238:239], v11 offset:53760
    s_add_u32 m0, s84, 32768
    s_add_u32 s93, s33, 27648
    buffer_load_dwordx4 v4, s[48:51], s33 offen offset:0 lds
    v_mfma_f32_32x32x16_bf16 v[96:111], a[228:231], a[32:35], v[96:111]
    buffer_load_dwordx4 v4, s[48:51], s93 offen offset:1024 lds
    v_mul_f32 v252, v250, v249
    v_mfma_f32_32x32x16_bf16 v[112:127], a[228:231], a[144:147], v[112:127]
    buffer_load_dwordx4 v5, s[52:55], s33 offen offset:2048 lds
    s_waitcnt lgkmcnt(0)
    v_mfma_f32_32x32x16_bf16 v[64:79], a[232:235], a[36:39], v[64:79]
    v_add_u32 v16, 0xc000, v16
    ds_read_b128 a[40:43], v16 offset:32768
    ds_read_b64_tr_b16 a[224:225], v10 offset:57344
    ds_read_b64_tr_b16 a[226:227], v10 offset:57856
    buffer_load_dwordx4 v5, s[52:55], s93 offen offset:3072 lds
    v_mul_f32 v251, 0x3fb8aa3b, v251
    v_mfma_f32_32x32x16_bf16 v[80:95], a[232:235], a[148:151], v[80:95]
    v_add_u32 v230, 0xc000, v230
    ds_read_b128 a[152:155], v230 offset:32768
    ds_read_b64_tr_b16 a[228:229], v11 offset:57344
    ds_read_b64_tr_b16 a[230:231], v11 offset:57856
    v_mul_f32 v252, 0.15915494, v252
    v_mul_f32 v254, 0x41800000, v253
    v_mfma_f32_32x32x16_bf16 v[96:111], a[236:239], a[36:39], v[96:111]
    v_mul_f32 v255, 0x43800000, v253
    v_mul_f32 v237, 1.0, v252
    v_mul_f32 v238, 0x41800000, v252
    v_mul_f32 v239, 0x43000000, v252
    v_mul_f32 v240, v254, v252
    v_mul_f32 v241, v255, v252
    v_mfma_f32_32x32x16_bf16 v[112:127], a[236:239], a[148:151], v[112:127]
    v_mul_f32 v232, 1.0, v251
    v_rndne_f32 v242, v237
    v_mul_f32 v233, 0x41800000, v251
    v_rndne_f32 v243, v238
    v_mul_f32 v234, 0x43000000, v251
    s_waitcnt lgkmcnt(0)
    v_mfma_f32_32x32x16_bf16 v[64:79], a[224:227], a[40:43], v[64:79]
    v_add_u32 v17, 0xc000, v17
    ds_read_b128 a[44:47], v17 offset:32768
    ds_read_b64_tr_b16 a[232:233], v10 offset:61440
    ds_read_b64_tr_b16 a[234:235], v10 offset:61952
    v_rndne_f32 v244, v239
    v_mul_f32 v235, v254, v251
    v_mfma_f32_32x32x16_bf16 v[80:95], a[224:227], a[152:155], v[80:95]
    v_add_u32 v231, 0xc000, v231
    ds_read_b128 a[156:159], v231 offset:32768
    ds_read_b64_tr_b16 a[236:237], v11 offset:61440
    ds_read_b64_tr_b16 a[238:239], v11 offset:61952
    v_rndne_f32 v245, v240
    v_mul_f32 v236, v255, v251
    v_mfma_f32_32x32x16_bf16 v[96:111], a[228:231], a[40:43], v[96:111]
    v_rndne_f32 v246, v241
    v_exp_f32 v232, v232
    v_sub_f32 v237, v237, v242
    v_exp_f32 v233, v233
    v_sub_f32 v238, v238, v243
    v_mfma_f32_32x32x16_bf16 v[112:127], a[228:231], a[152:155], v[112:127]
    v_exp_f32 v234, v234
    v_sub_f32 v239, v239, v244
    v_exp_f32 v235, v235
    v_sub_f32 v240, v240, v245
    s_waitcnt lgkmcnt(0)
    v_mfma_f32_32x32x16_bf16 v[64:79], a[232:235], a[44:47], v[64:79]
    s_waitcnt vmcnt(12)
    s_barrier
    s_add_u32 m0, s84, 49152
    v_add_u32 v62, s27, v2
    v_add_u32 v61, s27, v3
    buffer_load_dwordx4 v62, s[44:47], 0 offen offset:0 lds
    v_mfma_f32_32x32x16_bf16 v[80:95], a[232:235], a[156:159], v[80:95]
    v_add_u32 v14, 0xc000, v14
    ds_read_b128 a[48:51], v14 offset:16384
    v_add_u32 v10, 0xc000, v10
    ds_read_b64_tr_b16 a[224:225], v10 offset:32768
    ds_read_b64_tr_b16 a[226:227], v10 offset:33280
    buffer_load_dwordx4 v61, s[44:47], s86 offen offset:1024 lds
    v_exp_f32 v236, v236
    v_mfma_f32_32x32x16_bf16 v[96:111], a[236:239], a[44:47], v[96:111]
    v_add_u32 v228, 0xc000, v228
    ds_read_b128 a[160:163], v228 offset:16384
    v_add_u32 v11, 0xc000, v11
    ds_read_b64_tr_b16 a[228:229], v11 offset:32768
    ds_read_b64_tr_b16 a[230:231], v11 offset:33280
    buffer_load_dwordx4 v62, s[44:47], s87 offen offset:2048 lds
    v_mfma_f32_32x32x16_bf16 v[112:127], a[236:239], a[156:159], v[112:127]
    buffer_load_dwordx4 v61, s[44:47], s88 offen offset:3072 lds
    v_sub_f32 v241, v241, v246
    s_waitcnt lgkmcnt(3)
    v_mfma_f32_32x32x16_bf16 v[64:79], a[224:227], a[48:51], v[64:79]
    v_add_u32 v15, 0xc000, v15
    ds_read_b128 a[52:55], v15 offset:16384
    ds_read_b64_tr_b16 a[232:233], v10 offset:36864
    ds_read_b64_tr_b16 a[234:235], v10 offset:37376
    s_add_u32 m0, s84, 65536
    s_add_u32 s93, s34, 27648
    buffer_load_dwordx4 v4, s[48:51], s34 offen offset:0 lds
    s_waitcnt lgkmcnt(3)
    v_mfma_f32_32x32x16_bf16 v[80:95], a[224:227], a[160:163], v[80:95]
    v_add_u32 v229, 0xc000, v229
    ds_read_b128 a[164:167], v229 offset:16384
    ds_read_b64_tr_b16 a[236:237], v11 offset:36864
    ds_read_b64_tr_b16 a[238:239], v11 offset:37376
    buffer_load_dwordx4 v4, s[48:51], s93 offen offset:1024 lds
    v_cos_f32 v242, v237
    v_mfma_f32_32x32x16_bf16 v[96:111], a[228:231], a[48:51], v[96:111]
    buffer_load_dwordx4 v5, s[52:55], s34 offen offset:2048 lds
    v_sin_f32 v237, v237
    v_mfma_f32_32x32x16_bf16 v[112:127], a[228:231], a[160:163], v[112:127]
    buffer_load_dwordx4 v5, s[52:55], s93 offen offset:3072 lds
    s_waitcnt lgkmcnt(0)
    v_mfma_f32_32x32x16_bf16 v[64:79], a[232:235], a[52:55], v[64:79]
    v_add_u32 v16, 0xc000, v16
    ds_read_b128 a[56:59], v16 offset:16384
    ds_read_b64_tr_b16 a[224:225], v10 offset:40960
    ds_read_b64_tr_b16 a[226:227], v10 offset:41472
    v_cos_f32 v243, v238
    v_mfma_f32_32x32x16_bf16 v[80:95], a[232:235], a[164:167], v[80:95]
    v_add_u32 v230, 0xc000, v230
    ds_read_b128 a[168:171], v230 offset:16384
    ds_read_b64_tr_b16 a[228:229], v11 offset:40960
    ds_read_b64_tr_b16 a[230:231], v11 offset:41472
    v_sin_f32 v238, v238
    v_mfma_f32_32x32x16_bf16 v[96:111], a[236:239], a[52:55], v[96:111]
    v_cos_f32 v244, v239
    v_sin_f32 v239, v239
    v_cos_f32 v245, v240
    v_mfma_f32_32x32x16_bf16 v[112:127], a[236:239], a[164:167], v[112:127]
    v_sin_f32 v240, v240
    v_cos_f32 v246, v241
    v_sin_f32 v241, v241
    s_waitcnt lgkmcnt(0)
    v_mfma_f32_32x32x16_bf16 v[64:79], a[224:227], a[56:59], v[64:79]
    v_add_u32 v17, 0xc000, v17
    ds_read_b128 a[60:63], v17 offset:16384
    ds_read_b64_tr_b16 a[232:233], v10 offset:45056
    ds_read_b64_tr_b16 a[234:235], v10 offset:45568
    v_mul_f32 v40, v232, v242
    v_mul_f32 v41, v232, v237
    v_mfma_f32_32x32x16_bf16 v[80:95], a[224:227], a[168:171], v[80:95]
    v_add_u32 v231, 0xc000, v231
    ds_read_b128 a[172:175], v231 offset:16384
    ds_read_b64_tr_b16 a[236:237], v11 offset:45056
    ds_read_b64_tr_b16 a[238:239], v11 offset:45568
    v_mul_f32 v42, v233, v243
    v_mul_f32 v43, v233, v238
    v_mfma_f32_32x32x16_bf16 v[96:111], a[228:231], a[56:59], v[96:111]
    v_mul_f32 v44, v234, v244
    v_mul_f32 v45, v234, v239
    v_mul_f32 v46, v235, v245
    v_mul_f32 v47, v235, v240
    v_mul_f32 v48, v236, v246
    v_mul_f32 v49, v236, v241
    v_mul_f32 v224, v248, v248
    v_mfma_f32_32x32x16_bf16 v[112:127], a[228:231], a[168:171], v[112:127]
    v_add_f32 v225, -1.0, v40
    v_fmac_f32 v224, v249, v249
    v_rcp_f32 v224, v224
    v_mul_f32 v226, v225, v248
    v_mul_f32 v227, v41, v248
    s_waitcnt lgkmcnt(0)
    v_mfma_f32_32x32x16_bf16 v[64:79], a[232:235], a[60:63], v[64:79]
    s_waitcnt vmcnt(8)
    s_barrier
    s_add_u32 m0, s84, 81920
    v_add_u32 v62, s28, v2
    v_add_u32 v61, s28, v3
    buffer_load_dwordx4 v62, s[44:47], 0 offen offset:0 lds
    v_mfma_f32_32x32x16_bf16 v[80:95], a[232:235], a[172:175], v[80:95]
    v_subrev_u32 v14, 0x18000, v14
    ds_read_b128 a[64:67], v14 offset:16384
    v_subrev_u32 v10, 0x18000, v10
    ds_read_b64_tr_b16 a[224:225], v10 offset:32768
    ds_read_b64_tr_b16 a[226:227], v10 offset:33280
    buffer_load_dwordx4 v61, s[44:47], s86 offen offset:1024 lds
    v_add_f32 v224, v224, v224
    v_mfma_f32_32x32x16_bf16 v[96:111], a[236:239], a[60:63], v[96:111]
    v_subrev_u32 v228, 0x18000, v228
    ds_read_b128 a[176:179], v228 offset:16384
    v_subrev_u32 v11, 0x18000, v11
    ds_read_b64_tr_b16 a[228:229], v11 offset:32768
    ds_read_b64_tr_b16 a[230:231], v11 offset:33280
    buffer_load_dwordx4 v62, s[44:47], s87 offen offset:2048 lds
    v_mfma_f32_32x32x16_bf16 v[112:127], a[236:239], a[172:175], v[112:127]
    buffer_load_dwordx4 v61, s[44:47], s88 offen offset:3072 lds
    v_fmac_f32 v226, v41, v249
    s_waitcnt lgkmcnt(3)
    v_mfma_f32_32x32x16_bf16 v[64:79], a[224:227], a[64:67], v[64:79]
    v_subrev_u32 v15, 0x18000, v15
    ds_read_b128 a[68:71], v15 offset:16384
    ds_read_b64_tr_b16 a[232:233], v10 offset:36864
    ds_read_b64_tr_b16 a[234:235], v10 offset:37376
    s_add_u32 m0, s84, 98304
    s_add_u32 s93, s35, 27648
    buffer_load_dwordx4 v4, s[48:51], s35 offen offset:0 lds
    s_waitcnt lgkmcnt(3)
    v_mfma_f32_32x32x16_bf16 v[80:95], a[224:227], a[176:179], v[80:95]
    v_subrev_u32 v229, 0x18000, v229
    ds_read_b128 a[180:183], v229 offset:16384
    ds_read_b64_tr_b16 a[236:237], v11 offset:36864
    ds_read_b64_tr_b16 a[238:239], v11 offset:37376
    buffer_load_dwordx4 v4, s[48:51], s93 offen offset:1024 lds
    v_fma_f32 v227, -v225, v249, v227
    v_mfma_f32_32x32x16_bf16 v[96:111], a[228:231], a[64:67], v[96:111]
    buffer_load_dwordx4 v5, s[52:55], s35 offen offset:2048 lds
    v_mul_f32 v50, v226, v224
    v_mul_f32 v51, v227, v224
    v_mfma_f32_32x32x16_bf16 v[112:127], a[228:231], a[176:179], v[112:127]
    buffer_load_dwordx4 v5, s[52:55], s93 offen offset:3072 lds
    s_waitcnt lgkmcnt(0)
    v_mfma_f32_32x32x16_bf16 v[64:79], a[232:235], a[68:71], v[64:79]
    v_subrev_u32 v16, 0x18000, v16
    ds_read_b128 a[72:75], v16 offset:16384
    ds_read_b64_tr_b16 a[224:225], v10 offset:40960
    ds_read_b64_tr_b16 a[226:227], v10 offset:41472
    s_mov_b32 s3, 0x9e3779b1
    v_mul_lo_u32 v59, v59, s3
    v_mfma_f32_32x32x16_bf16 v[80:95], a[232:235], a[180:183], v[80:95]
    v_subrev_u32 v230, 0x18000, v230
    ds_read_b128 a[184:187], v230 offset:16384
    ds_read_b64_tr_b16 a[228:229], v11 offset:40960
    ds_read_b64_tr_b16 a[230:231], v11 offset:41472
    v_add_u32 v59, 0x7f4a7c15, v59
    v_and_b32 v37, v37, v59
    v_mfma_f32_32x32x16_bf16 v[96:111], a[236:239], a[68:71], v[96:111]
    v_and_b32 v38, v38, v59
    v_sub_f32 v12, 0, v41
    v_sub_f32 v13, 0, v51
    s_lshl_b32 s3, s82, 1
    s_add_u32 s3, s3, s83
    s_lshl_b32 s3, s3, 6
    v_and_b32 v224, 7, v1
    v_mfma_f32_32x32x16_bf16 v[112:127], a[236:239], a[180:183], v[112:127]
    v_lshl_add_u32 v224, v224, 3, s3
    global_load_dwordx2 v[250:251], v224, s[18:19]
    s_movk_i32 s10, 384
    s_waitcnt lgkmcnt(0)
    v_mfma_f32_32x32x16_bf16 v[64:79], a[224:227], a[72:75], v[64:79]
    v_subrev_u32 v17, 0x18000, v17
    ds_read_b128 a[76:79], v17 offset:16384
    ds_read_b64_tr_b16 a[232:233], v10 offset:45056
    ds_read_b64_tr_b16 a[234:235], v10 offset:45568
    s_lshl_b32 s16, s83, 11
    s_add_u32 s16, s16, 12288
    v_mfma_f32_32x32x16_bf16 v[80:95], a[224:227], a[184:187], v[80:95]
    v_subrev_u32 v231, 0x18000, v231
    ds_read_b128 a[188:191], v231 offset:16384
    ds_read_b64_tr_b16 a[236:237], v11 offset:45056
    ds_read_b64_tr_b16 a[238:239], v11 offset:45568
    s_mul_i32 s4, s82, 0
    s_add_u32 s5, s4, 8192
    v_mfma_f32_32x32x16_bf16 v[96:111], a[228:231], a[72:75], v[96:111]
    s_cmp_eq_u32 s5, 57344
    s_cselect_b32 s5, 0, s5
    s_add_u32 s9, s5, 8192
    s_cmp_eq_u32 s9, 57344
    s_cselect_b32 s9, 0, s9
    s_add_u32 s17, s9, 8192
    v_mfma_f32_32x32x16_bf16 v[112:127], a[228:231], a[184:187], v[112:127]
    s_cmp_eq_u32 s17, 57344
    s_cselect_b32 s17, 0, s17
    s_add_u32 s20, s17, 8192
    s_cmp_eq_u32 s20, 57344
    s_cselect_b32 s20, 0, s20
    s_waitcnt lgkmcnt(0)
    v_mfma_f32_32x32x16_bf16 v[64:79], a[232:235], a[76:79], v[64:79]
    s_waitcnt vmcnt(9)
    s_barrier
    s_add_u32 m0, s85, 114688
    v_add_u32 v62, s24, v6
    buffer_load_dwordx4 v62, s[56:59], 0 offen offset:0 lds
    v_mfma_f32_32x32x16_bf16 v[80:95], a[232:235], a[188:191], v[80:95]
    ds_read_b128 a[80:83], v14 offset:49152
    v_add_u32 v10, 0xc000, v10
    ds_read_b64_tr_b16 a[224:225], v10 offset:16384
    ds_read_b64_tr_b16 a[226:227], v10 offset:16896
    buffer_load_dwordx4 v62, s[60:63], 0 offen offset:1024 lds
    s_add_u32 s21, s20, 8192
    v_mfma_f32_32x32x16_bf16 v[96:111], a[236:239], a[76:79], v[96:111]
    ds_read_b128 a[192:195], v228 offset:49152
    v_add_u32 v11, 0xc000, v11
    ds_read_b64_tr_b16 a[228:229], v11 offset:16384
    ds_read_b64_tr_b16 a[230:231], v11 offset:16896
    s_add_u32 m0, s85, 122880
    v_add_u32 v62, s25, v6
    buffer_load_dwordx4 v62, s[56:59], 0 offen offset:0 lds
    v_mfma_f32_32x32x16_bf16 v[112:127], a[236:239], a[188:191], v[112:127]
    buffer_load_dwordx4 v62, s[60:63], 0 offen offset:1024 lds
    s_cmp_eq_u32 s21, 57344
    s_cselect_b32 s21, 0, s21
    s_waitcnt lgkmcnt(3)
    v_mfma_f32_32x32x16_bf16 v[64:79], a[224:227], a[80:83], v[64:79]
    ds_read_b128 a[84:87], v15 offset:49152
    ds_read_b64_tr_b16 a[232:233], v10 offset:20480
    ds_read_b64_tr_b16 a[234:235], v10 offset:20992
    s_add_u32 m0, s85, 131072
    v_add_u32 v62, s26, v6
    buffer_load_dwordx4 v62, s[56:59], 0 offen offset:0 lds
    s_waitcnt lgkmcnt(3)
    v_mfma_f32_32x32x16_bf16 v[80:95], a[224:227], a[192:195], v[80:95]
    ds_read_b128 a[196:199], v229 offset:49152
    ds_read_b64_tr_b16 a[236:237], v11 offset:20480
    ds_read_b64_tr_b16 a[238:239], v11 offset:20992
    buffer_load_dwordx4 v62, s[60:63], 0 offen offset:1024 lds
    s_add_u32 s90, s21, 8192
    v_mfma_f32_32x32x16_bf16 v[96:111], a[228:231], a[80:83], v[96:111]
    s_add_u32 m0, s85, 139264
    v_add_u32 v62, s27, v6
    buffer_load_dwordx4 v62, s[56:59], 0 offen offset:0 lds
    v_mfma_f32_32x32x16_bf16 v[112:127], a[228:231], a[192:195], v[112:127]
    buffer_load_dwordx4 v62, s[60:63], 0 offen offset:1024 lds
    s_cmp_eq_u32 s90, 57344
    s_cselect_b32 s90, 0, s90
    s_waitcnt lgkmcnt(0)
    v_mfma_f32_32x32x16_bf16 v[64:79], a[232:235], a[84:87], v[64:79]
    ds_read_b128 a[88:91], v16 offset:49152
    ds_read_b64_tr_b16 a[224:225], v10 offset:24576
    ds_read_b64_tr_b16 a[226:227], v10 offset:25088
    s_mul_i32 s3, s82, 0
    s_and_b32 s11, s3, 1
    v_mfma_f32_32x32x16_bf16 v[80:95], a[232:235], a[196:199], v[80:95]
    ds_read_b128 a[200:203], v230 offset:49152
    ds_read_b64_tr_b16 a[228:229], v11 offset:24576
    ds_read_b64_tr_b16 a[230:231], v11 offset:25088
    s_lshr_b32 s3, s3, 1
    v_mfma_f32_32x32x16_bf16 v[96:111], a[236:239], a[84:87], v[96:111]
    s_cmp_eq_u32 s3, 3
    s_cselect_b32 s3, 0, s3
    s_lshl_b32 s91, s83, 2
    s_add_u32 s91, s91, s3
    s_lshl_b32 s91, s91, 7
    s_add_u32 s3, s3, 1
    v_mfma_f32_32x32x16_bf16 v[112:127], a[236:239], a[196:199], v[112:127]
    s_cmp_eq_u32 s3, 3
    s_cselect_b32 s3, 0, s3
    s_lshl_b32 s39, s83, 2
    s_add_u32 s39, s39, s3
    s_lshl_b32 s39, s39, 7
    s_add_u32 s3, s3, 1
    s_waitcnt lgkmcnt(0)
    v_mfma_f32_32x32x16_bf16 v[64:79], a[224:227], a[88:91], v[64:79]
    ds_read_b128 a[92:95], v17 offset:49152
    ds_read_b64_tr_b16 a[232:233], v10 offset:28672
    ds_read_b64_tr_b16 a[234:235], v10 offset:29184
    s_cmp_eq_u32 s3, 3
    s_cselect_b32 s3, 0, s3
    v_mfma_f32_32x32x16_bf16 v[80:95], a[224:227], a[200:203], v[80:95]
    ds_read_b128 a[204:207], v231 offset:49152
    ds_read_b64_tr_b16 a[236:237], v11 offset:28672
    ds_read_b64_tr_b16 a[238:239], v11 offset:29184
    s_lshl_b32 s40, s83, 2
    s_add_u32 s40, s40, s3
    v_mfma_f32_32x32x16_bf16 v[96:111], a[228:231], a[88:91], v[96:111]
    s_lshl_b32 s40, s40, 7
    v_mfma_f32_32x32x16_bf16 v[112:127], a[228:231], a[200:203], v[112:127]
    s_waitcnt lgkmcnt(0)
    v_mfma_f32_32x32x16_bf16 v[64:79], a[232:235], a[92:95], v[64:79]
    s_waitcnt vmcnt(9)
    s_barrier
    s_add_u32 m0, s85, 16384
    v_add_u32 v62, s28, v6
    buffer_load_dwordx4 v62, s[56:59], 0 offen offset:0 lds
    s_cmp_eq_u32 s11, 1
    s_cselect_b32 s3, s12, s68
    s_cselect_b32 s12, s68, s12
    s_mov_b32 s68, s3
    s_cselect_b32 s3, s13, s69
    s_cselect_b32 s13, s69, s13
    s_mov_b32 s69, s3
    v_mfma_f32_32x32x16_bf16 v[80:95], a[232:235], a[204:207], v[80:95]
    v_add_u32 v14, 0xc000, v14
    ds_read_b128 a[96:99], v14 offset:32768
    ds_read_b64_tr_b16 a[224:225], v10 offset:49152
    ds_read_b64_tr_b16 a[226:227], v10 offset:49664
    buffer_load_dwordx4 v62, s[60:63], 0 offen offset:1024 lds
    v_mfma_f32_32x32x16_bf16 v[96:111], a[236:239], a[92:95], v[96:111]
    v_add_u32 v228, 0xc000, v228
    ds_read_b128 a[208:211], v228 offset:32768
    ds_read_b64_tr_b16 a[228:229], v11 offset:49152
    ds_read_b64_tr_b16 a[230:231], v11 offset:49664
    s_add_u32 m0, s84, 32768
    s_add_u32 s93, s29, 27648
    v_add_u32 v4, 128, v4
    v_add_u32 v5, 128, v5
    buffer_load_dwordx4 v4, s[48:51], s29 offen offset:0 lds
    s_mul_i32 s11, s11, 28672
    v_mfma_f32_32x32x16_bf16 v[112:127], a[236:239], a[204:207], v[112:127]
    buffer_load_dwordx4 v4, s[48:51], s93 offen offset:1024 lds
    s_waitcnt lgkmcnt(3)
    v_mfma_f32_32x32x16_bf16 v[64:79], a[224:227], a[96:99], v[64:79]
    v_add_u32 v15, 0xc000, v15
    ds_read_b128 a[100:103], v15 offset:32768
    ds_read_b64_tr_b16 a[232:233], v10 offset:53248
    ds_read_b64_tr_b16 a[234:235], v10 offset:53760
    buffer_load_dwordx4 v5, s[52:55], s29 offen offset:2048 lds
    s_sub_u32 s8, 28672, s11
    s_waitcnt lgkmcnt(3)
    v_mfma_f32_32x32x16_bf16 v[80:95], a[224:227], a[208:211], v[80:95]
    v_add_u32 v229, 0xc000, v229
    ds_read_b128 a[212:215], v229 offset:32768
    ds_read_b64_tr_b16 a[236:237], v11 offset:53248
    ds_read_b64_tr_b16 a[238:239], v11 offset:53760
    buffer_load_dwordx4 v5, s[52:55], s93 offen offset:3072 lds
    v_mfma_f32_32x32x16_bf16 v[96:111], a[228:231], a[96:99], v[96:111]
    v_mfma_f32_32x32x16_bf16 v[112:127], a[228:231], a[208:211], v[112:127]
    s_waitcnt lgkmcnt(0)
    v_mfma_f32_32x32x16_bf16 v[64:79], a[232:235], a[100:103], v[64:79]
    v_add_u32 v16, 0xc000, v16
    ds_read_b128 a[104:107], v16 offset:32768
    ds_read_b64_tr_b16 a[224:225], v10 offset:57344
    ds_read_b64_tr_b16 a[226:227], v10 offset:57856
    v_mfma_f32_32x32x16_bf16 v[80:95], a[232:235], a[212:215], v[80:95]
    v_add_u32 v230, 0xc000, v230
    ds_read_b128 a[216:219], v230 offset:32768
    ds_read_b64_tr_b16 a[228:229], v11 offset:57344
    ds_read_b64_tr_b16 a[230:231], v11 offset:57856
    v_mfma_f32_32x32x16_bf16 v[96:111], a[236:239], a[100:103], v[96:111]
    v_mfma_f32_32x32x16_bf16 v[112:127], a[236:239], a[212:215], v[112:127]
    s_waitcnt lgkmcnt(0)
    v_mfma_f32_32x32x16_bf16 v[64:79], a[224:227], a[104:107], v[64:79]
    v_add_u32 v17, 0xc000, v17
    ds_read_b128 a[108:111], v17 offset:32768
    ds_read_b64_tr_b16 a[232:233], v10 offset:61440
    ds_read_b64_tr_b16 a[234:235], v10 offset:61952
    v_mfma_f32_32x32x16_bf16 v[80:95], a[224:227], a[216:219], v[80:95]
    s_waitcnt vmcnt(10)
    s_barrier
    v_add_u32 v231, 0xc000, v231
    ds_read_b128 a[220:223], v231 offset:32768
    ds_read_b64_tr_b16 a[236:237], v11 offset:61440
    ds_read_b64_tr_b16 a[238:239], v11 offset:61952
    s_add_u32 m0, s84, 49152
    s_add_u32 s93, s30, 27648
    buffer_load_dwordx4 v4, s[48:51], s30 offen offset:0 lds
    v_mfma_f32_32x32x16_bf16 v[96:111], a[228:231], a[104:107], v[96:111]
    v_add_u32 v18, 0x18000, v18
    ds_read_b128 a[240:243], v18 offset:49152
    ds_read_b128 a[244:247], v18 offset:50176
    buffer_load_dwordx4 v4, s[48:51], s93 offen offset:1024 lds
    v_mfma_f32_32x32x16_bf16 v[112:127], a[228:231], a[216:219], v[112:127]
    buffer_load_dwordx4 v5, s[52:55], s30 offen offset:2048 lds
    s_waitcnt lgkmcnt(2)
    v_mfma_f32_32x32x16_bf16 v[64:79], a[232:235], a[108:111], v[64:79]
    v_add_u32 v19, 0x18000, v19
    ds_read_b128 a[248:251], v19 offset:49152
    ds_read_b128 a[252:255], v19 offset:50176
    buffer_load_dwordx4 v5, s[52:55], s93 offen offset:3072 lds
    v_mfma_f32_32x32x16_bf16 v[80:95], a[232:235], a[220:223], v[80:95]
    s_add_u32 m0, s84, 65536
    s_add_u32 s93, s31, 27648
    buffer_load_dwordx4 v4, s[48:51], s31 offen offset:0 lds
    v_mfma_f32_32x32x16_bf16 v[96:111], a[236:239], a[108:111], v[96:111]
    v_add_u32 v20, 0x18000, v20
    ds_read_b128 a[224:227], v20 offset:49152
    ds_read_b128 a[228:231], v20 offset:50176
    v_mfma_f32_32x32x16_bf16 v[112:127], a[236:239], a[220:223], v[112:127]
    buffer_load_dwordx4 v4, s[48:51], s93 offen offset:1024 lds
    s_waitcnt lgkmcnt(2)
    v_mfma_f32_32x32x16_bf16 v[128:143], a[0:3], a[240:243], 0
    v_add_u32 v21, 0x18000, v21
    ds_read_b128 a[232:235], v21 offset:49152
    ds_read_b128 a[236:239], v21 offset:50176
    buffer_load_dwordx4 v5, s[52:55], s31 offen offset:2048 lds
    v_mfma_f32_32x32x16_bf16 v[144:159], a[0:3], a[244:247], 0
    v_mfma_f32_32x32x16_bf16 v[128:143], a[4:7], a[248:251], v[128:143]
    ds_read_b128 a[240:243], v18 offset:57344
    ds_read_b128 a[244:247], v18 offset:58368
    buffer_load_dwordx4 v5, s[52:55], s93 offen offset:3072 lds
    v_mul_f32 v64, s92, v64
    v_mul_f32 v65, s92, v65
    v_mfma_f32_32x32x16_bf16 v[144:159], a[4:7], a[252:255], v[144:159]
    v_mul_f32 v66, s92, v66
    v_mul_f32 v67, s92, v67
    v_exp_f32 v64, v64
    v_exp_f32 v65, v65
    v_exp_f32 v66, v66
    s_waitcnt lgkmcnt(2)
    v_mfma_f32_32x32x16_bf16 v[128:143], a[8:11], a[224:227], v[128:143]
    ds_read_b128 a[248:251], v19 offset:57344
    ds_read_b128 a[252:255], v19 offset:58368
    v_exp_f32 v67, v67
    v_add_f32 v64, 1.0, v64
    v_add_f32 v65, 1.0, v65
    v_add_f32 v66, 1.0, v66
    v_add_f32 v67, 1.0, v67
    v_mfma_f32_32x32x16_bf16 v[144:159], a[8:11], a[228:231], v[144:159]
    v_rcp_f32 v64, v64
    v_rcp_f32 v65, v65
    v_rcp_f32 v66, v66
    v_rcp_f32 v67, v67
    v_mul_f32 v64, v64, v72
    v_mul_f32 v65, v65, v73
    v_mfma_f32_32x32x16_bf16 v[128:143], a[12:15], a[232:235], v[128:143]
    ds_read_b128 a[224:227], v20 offset:57344
    ds_read_b128 a[228:231], v20 offset:58368
    v_mul_f32 v66, v66, v74
    v_mul_f32 v67, v67, v75
    v_cvt_pk_bf16_f32 v64, v64, v65
    v_cvt_pk_bf16_f32 v65, v66, v67
    v_mul_f32 v68, s92, v68
    v_mul_f32 v69, s92, v69
    v_mfma_f32_32x32x16_bf16 v[144:159], a[12:15], a[236:239], v[144:159]
    v_mul_f32 v70, s92, v70
    v_mul_f32 v71, s92, v71
    v_exp_f32 v68, v68
    v_exp_f32 v69, v69
    v_exp_f32 v70, v70
    s_waitcnt lgkmcnt(2)
    v_mfma_f32_32x32x16_bf16 v[128:143], a[16:19], a[240:243], v[128:143]
    ds_read_b128 a[232:235], v21 offset:57344
    ds_read_b128 a[236:239], v21 offset:58368
    v_exp_f32 v71, v71
    v_add_f32 v68, 1.0, v68
    v_add_f32 v69, 1.0, v69
    v_add_f32 v70, 1.0, v70
    v_add_f32 v71, 1.0, v71
    v_mfma_f32_32x32x16_bf16 v[144:159], a[16:19], a[244:247], v[144:159]
    v_rcp_f32 v68, v68
    v_rcp_f32 v69, v69
    v_rcp_f32 v70, v70
    v_rcp_f32 v71, v71
    v_mul_f32 v68, v68, v76
    v_mul_f32 v69, v69, v77
    v_mfma_f32_32x32x16_bf16 v[128:143], a[20:23], a[248:251], v[128:143]
    ds_read_b128 a[240:243], v18 offset:16384
    ds_read_b128 a[244:247], v18 offset:17408
    v_mul_f32 v70, v70, v78
    v_mul_f32 v71, v71, v79
    v_cvt_pk_bf16_f32 v66, v68, v69
    v_cvt_pk_bf16_f32 v67, v70, v71
    v_mul_f32 v80, s92, v80
    v_mul_f32 v81, s92, v81
    v_mfma_f32_32x32x16_bf16 v[144:159], a[20:23], a[252:255], v[144:159]
    buffer_store_dwordx4 v[64:67], v28, s[72:75], s36 offen offset:0 sc1
    v_mul_f32 v82, s92, v82
    v_mul_f32 v83, s92, v83
    s_waitcnt lgkmcnt(2)
    v_mfma_f32_32x32x16_bf16 v[128:143], a[24:27], a[224:227], v[128:143]
    ds_read_b128 a[248:251], v19 offset:16384
    ds_read_b128 a[252:255], v19 offset:17408
    v_exp_f32 v80, v80
    v_exp_f32 v81, v81
    v_exp_f32 v82, v82
    v_mfma_f32_32x32x16_bf16 v[144:159], a[24:27], a[228:231], v[144:159]
    v_exp_f32 v83, v83
    v_add_f32 v80, 1.0, v80
    v_add_f32 v81, 1.0, v81
    v_add_f32 v82, 1.0, v82
    v_add_f32 v83, 1.0, v83
    v_rcp_f32 v80, v80
    v_rcp_f32 v81, v81
    v_mfma_f32_32x32x16_bf16 v[128:143], a[28:31], a[232:235], v[128:143]
    ds_read_b128 a[224:227], v20 offset:16384
    ds_read_b128 a[228:231], v20 offset:17408
    v_rcp_f32 v82, v82
    v_rcp_f32 v83, v83
    v_mul_f32 v80, v80, v88
    v_mul_f32 v81, v81, v89
    v_mul_f32 v82, v82, v90
    v_mfma_f32_32x32x16_bf16 v[144:159], a[28:31], a[236:239], v[144:159]
    v_mul_f32 v83, v83, v91
    v_cvt_pk_bf16_f32 v80, v80, v81
    v_cvt_pk_bf16_f32 v81, v82, v83
    v_mul_f32 v84, s92, v84
    v_mul_f32 v85, s92, v85
    v_mul_f32 v86, s92, v86
    v_mul_f32 v87, s92, v87
    s_waitcnt lgkmcnt(2)
    v_mfma_f32_32x32x16_bf16 v[128:143], a[32:35], a[240:243], v[128:143]
    ds_read_b128 a[232:235], v21 offset:16384
    ds_read_b128 a[236:239], v21 offset:17408
    v_exp_f32 v84, v84
    v_exp_f32 v85, v85
    v_exp_f32 v86, v86
    v_mfma_f32_32x32x16_bf16 v[144:159], a[32:35], a[244:247], v[144:159]
    v_exp_f32 v87, v87
    v_add_f32 v84, 1.0, v84
    v_add_f32 v85, 1.0, v85
    v_add_f32 v86, 1.0, v86
    v_add_f32 v87, 1.0, v87
    v_rcp_f32 v84, v84
    v_rcp_f32 v85, v85
    v_mfma_f32_32x32x16_bf16 v[128:143], a[36:39], a[248:251], v[128:143]
    ds_read_b128 a[240:243], v18 offset:24576
    ds_read_b128 a[244:247], v18 offset:25600
    v_rcp_f32 v86, v86
    v_rcp_f32 v87, v87
    v_mul_f32 v84, v84, v92
    v_mul_f32 v85, v85, v93
    v_mul_f32 v86, v86, v94
    v_mfma_f32_32x32x16_bf16 v[144:159], a[36:39], a[252:255], v[144:159]
    v_mul_f32 v87, v87, v95
    v_cvt_pk_bf16_f32 v82, v84, v85
    v_cvt_pk_bf16_f32 v83, v86, v87
    v_mul_f32 v96, s92, v96
    v_mul_f32 v97, s92, v97
    v_mul_f32 v98, s92, v98
    v_mul_f32 v99, s92, v99
    s_waitcnt lgkmcnt(2)
    v_mfma_f32_32x32x16_bf16 v[128:143], a[40:43], a[224:227], v[128:143]
    ds_read_b128 a[248:251], v19 offset:24576
    ds_read_b128 a[252:255], v19 offset:25600
    buffer_store_dwordx4 v[80:83], v28, s[72:75], s37 offen offset:0 sc1
    s_cmp_eq_u32 s83, 0
    s_cselect_b64 vcc, -1, 0
    v_cndmask_b32 v14, v24, v22, vcc
    v_cndmask_b32 v15, v25, v23, vcc
    v_mfma_f32_32x32x16_bf16 v[144:159], a[40:43], a[228:231], v[144:159]
    v_exp_f32 v96, v96
    v_exp_f32 v97, v97
    v_exp_f32 v98, v98
    v_exp_f32 v99, v99
    v_add_f32 v96, 1.0, v96
    v_add_f32 v97, 1.0, v97
    v_mfma_f32_32x32x16_bf16 v[128:143], a[44:47], a[232:235], v[128:143]
    ds_read_b128 a[224:227], v20 offset:24576
    ds_read_b128 a[228:231], v20 offset:25600
    v_add_f32 v98, 1.0, v98
    v_add_f32 v99, 1.0, v99
    v_rcp_f32 v96, v96
    v_rcp_f32 v97, v97
    v_mfma_f32_32x32x16_bf16 v[144:159], a[44:47], a[236:239], v[144:159]
    v_rcp_f32 v98, v98
    v_rcp_f32 v99, v99
    v_mul_f32 v96, v96, v104
    v_mul_f32 v97, v97, v105
    v_mul_f32 v98, v98, v106
    v_mul_f32 v99, v99, v107
    s_waitcnt lgkmcnt(2)
    v_mfma_f32_32x32x16_bf16 v[128:143], a[48:51], a[240:243], v[128:143]
    ds_read_b128 a[232:235], v21 offset:24576
    ds_read_b128 a[236:239], v21 offset:25600
    v_cvt_pk_bf16_f32 v96, v96, v97
    v_cvt_pk_bf16_f32 v97, v98, v99
    v_mul_f32 v100, s92, v100
    v_mul_f32 v101, s92, v101
    v_mul_f32 v102, s92, v102
    v_mul_f32 v103, s92, v103
    v_mfma_f32_32x32x16_bf16 v[144:159], a[48:51], a[244:247], v[144:159]
    s_waitcnt vmcnt(14)
    s_barrier
    s_add_u32 m0, s84, 81920
    s_add_u32 s93, s32, 27648
    buffer_load_dwordx4 v4, s[48:51], s32 offen offset:0 lds
    v_mfma_f32_32x32x16_bf16 v[128:143], a[52:55], a[248:251], v[128:143]
    ds_read_b128 a[240:243], v18 offset:32768
    ds_read_b128 a[244:247], v18 offset:33792
    buffer_load_dwordx4 v4, s[48:51], s93 offen offset:1024 lds
    v_exp_f32 v100, v100
    v_mfma_f32_32x32x16_bf16 v[144:159], a[52:55], a[252:255], v[144:159]
    buffer_load_dwordx4 v5, s[52:55], s32 offen offset:2048 lds
    v_exp_f32 v101, v101
    v_exp_f32 v102, v102
    s_waitcnt lgkmcnt(2)
    v_mfma_f32_32x32x16_bf16 v[128:143], a[56:59], a[224:227], v[128:143]
    ds_read_b128 a[248:251], v19 offset:32768
    ds_read_b128 a[252:255], v19 offset:33792
    v_exp_f32 v103, v103
    v_add_f32 v100, 1.0, v100
    v_add_f32 v101, 1.0, v101
    v_add_f32 v102, 1.0, v102
    v_add_f32 v103, 1.0, v103
    v_mfma_f32_32x32x16_bf16 v[144:159], a[56:59], a[228:231], v[144:159]
    buffer_load_dwordx4 v5, s[52:55], s93 offen offset:3072 lds
    v_rcp_f32 v100, v100
    v_rcp_f32 v101, v101
    v_mfma_f32_32x32x16_bf16 v[128:143], a[60:63], a[232:235], v[128:143]
    ds_read_b128 a[224:227], v20 offset:32768
    ds_read_b128 a[228:231], v20 offset:33792
    s_add_u32 m0, s84, 98304
    s_add_u32 s93, s33, 27648
    buffer_load_dwordx4 v4, s[48:51], s33 offen offset:0 lds
    v_mfma_f32_32x32x16_bf16 v[144:159], a[60:63], a[236:239], v[144:159]
    buffer_load_dwordx4 v4, s[48:51], s93 offen offset:1024 lds
    v_rcp_f32 v102, v102
    v_rcp_f32 v103, v103
    s_waitcnt lgkmcnt(2)
    v_mfma_f32_32x32x16_bf16 v[128:143], a[64:67], a[240:243], v[128:143]
    ds_read_b128 a[232:235], v21 offset:32768
    ds_read_b128 a[236:239], v21 offset:33792
    v_mul_f32 v100, v100, v108
    v_mul_f32 v101, v101, v109
    v_mul_f32 v102, v102, v110
    v_mul_f32 v103, v103, v111
    v_cvt_pk_bf16_f32 v98, v100, v101
    v_cvt_pk_bf16_f32 v99, v102, v103
    v_mfma_f32_32x32x16_bf16 v[144:159], a[64:67], a[244:247], v[144:159]
    buffer_store_dwordx4 v[96:99], v28, s[72:75], s36 offen offset:1024 sc1
    v_mul_f32 v112, s92, v112
    v_mul_f32 v113, s92, v113
    v_mul_f32 v114, s92, v114
    v_mfma_f32_32x32x16_bf16 v[128:143], a[68:71], a[248:251], v[128:143]
    ds_read_b128 a[240:243], v18 offset:40960
    ds_read_b128 a[244:247], v18 offset:41984
    v_mul_f32 v115, s92, v115
    v_exp_f32 v112, v112
    v_exp_f32 v113, v113
    v_exp_f32 v114, v114
    v_mfma_f32_32x32x16_bf16 v[144:159], a[68:71], a[252:255], v[144:159]
    buffer_load_dwordx4 v5, s[52:55], s33 offen offset:2048 lds
    v_exp_f32 v115, v115
    v_add_f32 v112, 1.0, v112
    v_add_f32 v113, 1.0, v113
    s_waitcnt lgkmcnt(2)
    v_mfma_f32_32x32x16_bf16 v[128:143], a[72:75], a[224:227], v[128:143]
    ds_read_b128 a[248:251], v19 offset:40960
    ds_read_b128 a[252:255], v19 offset:41984
    v_add_f32 v114, 1.0, v114
    v_add_f32 v115, 1.0, v115
    v_rcp_f32 v112, v112
    v_rcp_f32 v113, v113
    v_mfma_f32_32x32x16_bf16 v[144:159], a[72:75], a[228:231], v[144:159]
    buffer_load_dwordx4 v5, s[52:55], s93 offen offset:3072 lds
    v_rcp_f32 v114, v114
    v_rcp_f32 v115, v115
    v_mul_f32 v112, v112, v120
    v_mfma_f32_32x32x16_bf16 v[128:143], a[76:79], a[232:235], v[128:143]
    ds_read_b128 a[224:227], v20 offset:40960
    ds_read_b128 a[228:231], v20 offset:41984
    s_add_u32 m0, s84, 147456
    s_add_u32 s93, s34, 27648
    buffer_load_dwordx4 v4, s[48:51], s34 offen offset:0 lds
    v_mfma_f32_32x32x16_bf16 v[144:159], a[76:79], a[236:239], v[144:159]
    buffer_load_dwordx4 v4, s[48:51], s93 offen offset:1024 lds
    v_mul_f32 v113, v113, v121
    v_mul_f32 v114, v114, v122
    v_mul_f32 v115, v115, v123
    s_waitcnt lgkmcnt(2)
    v_mfma_f32_32x32x16_bf16 v[128:143], a[80:83], a[240:243], v[128:143]
    ds_read_b128 a[232:235], v21 offset:40960
    ds_read_b128 a[236:239], v21 offset:41984
    v_cvt_pk_bf16_f32 v112, v112, v113
    v_cvt_pk_bf16_f32 v113, v114, v115
    v_mul_f32 v116, s92, v116
    v_mul_f32 v117, s92, v117
    v_mul_f32 v118, s92, v118
    v_mul_f32 v119, s92, v119
    v_mfma_f32_32x32x16_bf16 v[144:159], a[80:83], a[244:247], v[144:159]
    buffer_load_dwordx4 v5, s[52:55], s34 offen offset:2048 lds
    v_exp_f32 v116, v116
    v_exp_f32 v117, v117
    v_mfma_f32_32x32x16_bf16 v[128:143], a[84:87], a[248:251], v[128:143]
    v_subrev_u32 v18, 0x18000, v18
    ds_read_b128 a[240:243], v18 offset:16384
    ds_read_b128 a[244:247], v18 offset:17408
    v_exp_f32 v118, v118
    v_exp_f32 v119, v119
    v_add_f32 v116, 1.0, v116
    v_add_f32 v117, 1.0, v117
    v_add_f32 v118, 1.0, v118
    v_mfma_f32_32x32x16_bf16 v[144:159], a[84:87], a[252:255], v[144:159]
    buffer_load_dwordx4 v5, s[52:55], s93 offen offset:3072 lds
    v_add_f32 v119, 1.0, v119
    v_rcp_f32 v116, v116
    s_waitcnt lgkmcnt(2)
    v_mfma_f32_32x32x16_bf16 v[128:143], a[88:91], a[224:227], v[128:143]
    v_subrev_u32 v19, 0x18000, v19
    ds_read_b128 a[248:251], v19 offset:16384
    ds_read_b128 a[252:255], v19 offset:17408
    v_rcp_f32 v117, v117
    v_rcp_f32 v118, v118
    v_rcp_f32 v119, v119
    v_mul_f32 v116, v116, v124
    v_mfma_f32_32x32x16_bf16 v[144:159], a[88:91], a[228:231], v[144:159]
    v_mul_f32 v117, v117, v125
    v_mul_f32 v118, v118, v126
    v_mul_f32 v119, v119, v127
    v_cvt_pk_bf16_f32 v114, v116, v117
    v_cvt_pk_bf16_f32 v115, v118, v119
    v_mfma_f32_32x32x16_bf16 v[128:143], a[92:95], a[232:235], v[128:143]
    v_subrev_u32 v20, 0x18000, v20
    ds_read_b128 a[224:227], v20 offset:16384
    ds_read_b128 a[228:231], v20 offset:17408
    buffer_store_dwordx4 v[112:115], v28, s[72:75], s37 offen offset:1024 sc1
    v_mfma_f32_32x32x16_bf16 v[144:159], a[92:95], a[236:239], v[144:159]
    s_waitcnt lgkmcnt(2)
    v_mfma_f32_32x32x16_bf16 v[128:143], a[96:99], a[240:243], v[128:143]
    v_subrev_u32 v21, 0x18000, v21
    ds_read_b128 a[232:235], v21 offset:16384
    ds_read_b128 a[236:239], v21 offset:17408
    v_mfma_f32_32x32x16_bf16 v[144:159], a[96:99], a[244:247], v[144:159]
    s_waitcnt vmcnt(24)
    s_barrier
    s_add_u32 m0, s84, 114688
    s_add_u32 s93, s35, 27648
    buffer_load_dwordx4 v4, s[48:51], s35 offen offset:0 lds
    v_mfma_f32_32x32x16_bf16 v[128:143], a[100:103], a[248:251], v[128:143]
    v_subrev_u32 v10, 0xc000, v10
    ds_read_b64_tr_b16 a[240:241], v10 offset:32768
    ds_read_b64_tr_b16 a[242:243], v10 offset:33280
    buffer_load_dwordx4 v4, s[48:51], s93 offen offset:1024 lds
    v_mfma_f32_32x32x16_bf16 v[144:159], a[100:103], a[252:255], v[144:159]
    buffer_load_dwordx4 v5, s[52:55], s35 offen offset:2048 lds
    s_waitcnt lgkmcnt(2)
    v_mfma_f32_32x32x16_bf16 v[128:143], a[104:107], a[224:227], v[128:143]
    v_subrev_u32 v11, 0xc000, v11
    ds_read_b64_tr_b16 a[244:245], v11 offset:32768
    ds_read_b64_tr_b16 a[246:247], v11 offset:33280
    v_mfma_f32_32x32x16_bf16 v[144:159], a[104:107], a[228:231], v[144:159]
    buffer_load_dwordx4 v5, s[52:55], s93 offen offset:3072 lds
    v_mfma_f32_32x32x16_bf16 v[128:143], a[108:111], a[232:235], v[128:143]
    ds_read_b64_tr_b16 a[248:249], v10 offset:36864
    ds_read_b64_tr_b16 a[250:251], v10 offset:37376
    v_mfma_f32_32x32x16_bf16 v[144:159], a[108:111], a[236:239], v[144:159]
    s_waitcnt lgkmcnt(2)
    v_mfma_f32_32x32x16_bf16 v[160:175], a[240:243], a[0:3], 0
    ds_read_b64_tr_b16 a[252:253], v11 offset:36864
    ds_read_b64_tr_b16 a[254:255], v11 offset:37376
    v_mfma_f32_32x32x16_bf16 v[176:191], a[240:243], a[112:115], 0
    v_mfma_f32_32x32x16_bf16 v[192:207], a[244:247], a[0:3], 0
    ds_read_b64_tr_b16 a[224:225], v10 offset:40960
    ds_read_b64_tr_b16 a[226:227], v10 offset:41472
    s_nop 0
    v_fma_f32 v226, v40, v128, v129
    s_nop 1
    v_fma_f32 v227, v40, v144, v145
    v_fmac_f32 v226, v12, v144
    v_fmac_f32 v227, v41, v128
    v_fma_f32 v224, v40, v226, v130
    v_fma_f32 v225, v40, v227, v146
    v_fmac_f32 v224, v12, v227
    v_fmac_f32 v225, v41, v226
    v_mfma_f32_32x32x16_bf16 v[208:223], a[244:247], a[112:115], 0
    v_fma_f32 v226, v40, v224, v131
    v_fma_f32 v227, v40, v225, v147
    v_fmac_f32 v226, v12, v225
    v_fmac_f32 v227, v41, v224
    v_fma_f32 v224, v40, v226, v132
    v_fma_f32 v225, v40, v227, v148
    v_fmac_f32 v224, v12, v227
    v_fmac_f32 v225, v41, v226
    v_fma_f32 v226, v40, v224, v133
    v_fma_f32 v227, v40, v225, v149
    s_waitcnt lgkmcnt(2)
    v_mfma_f32_32x32x16_bf16 v[160:175], a[248:251], a[4:7], v[160:175]
    ds_read_b64_tr_b16 a[228:229], v11 offset:40960
    ds_read_b64_tr_b16 a[230:231], v11 offset:41472
    v_fmac_f32 v226, v12, v225
    v_fmac_f32 v227, v41, v224
    v_fma_f32 v224, v40, v226, v134
    v_fma_f32 v225, v40, v227, v150
    v_fmac_f32 v224, v12, v227
    v_fmac_f32 v225, v41, v226
    v_fma_f32 v226, v40, v224, v135
    v_fma_f32 v227, v40, v225, v151
    v_fmac_f32 v226, v12, v225
    v_mfma_f32_32x32x16_bf16 v[176:191], a[248:251], a[116:119], v[176:191]
    v_fmac_f32 v227, v41, v224
    v_fma_f32 v224, v40, v226, v136
    v_fma_f32 v225, v40, v227, v152
    v_fmac_f32 v224, v12, v227
    v_fmac_f32 v225, v41, v226
    v_fma_f32 v226, v40, v224, v137
    v_fma_f32 v227, v40, v225, v153
    v_fmac_f32 v226, v12, v225
    v_fmac_f32 v227, v41, v224
    v_fma_f32 v224, v40, v226, v138
    v_fma_f32 v225, v40, v227, v154
    v_mfma_f32_32x32x16_bf16 v[192:207], a[252:255], a[4:7], v[192:207]
    ds_read_b64_tr_b16 a[232:233], v10 offset:45056
    ds_read_b64_tr_b16 a[234:235], v10 offset:45568
    v_fmac_f32 v224, v12, v227
    v_fmac_f32 v225, v41, v226
    v_fma_f32 v226, v40, v224, v139
    v_fma_f32 v227, v40, v225, v155
    v_fmac_f32 v226, v12, v225
    v_fmac_f32 v227, v41, v224
    v_fma_f32 v224, v40, v226, v140
    v_fma_f32 v225, v40, v227, v156
    v_fmac_f32 v224, v12, v227
    v_mfma_f32_32x32x16_bf16 v[208:223], a[252:255], a[116:119], v[208:223]
    v_fmac_f32 v225, v41, v226
    v_fma_f32 v226, v40, v224, v141
    v_fma_f32 v227, v40, v225, v157
    v_fmac_f32 v226, v12, v225
    v_fmac_f32 v227, v41, v224
    v_fma_f32 v224, v40, v226, v142
    v_fma_f32 v225, v40, v227, v158
    v_fmac_f32 v224, v12, v227
    v_fmac_f32 v225, v41, v226
    v_fma_f32 v226, v40, v224, v143
    s_waitcnt lgkmcnt(2)
    v_mfma_f32_32x32x16_bf16 v[160:175], a[224:227], a[8:11], v[160:175]
    ds_read_b64_tr_b16 a[236:237], v11 offset:45056
    ds_read_b64_tr_b16 a[238:239], v11 offset:45568
    v_fma_f32 v227, v40, v225, v159
    v_fmac_f32 v226, v12, v225
    v_fmac_f32 v227, v41, v224
    ds_write_b64 v55, v[226:227] offset:0
    v_mfma_f32_32x32x16_bf16 v[176:191], a[224:227], a[120:123], v[176:191]
    s_waitcnt vmcnt(24)
    s_barrier
    s_add_u32 m0, s85, 131072
    s_mul_i32 s93, s4, 14
    v_add_u32 v62, s93, v7
    buffer_load_dwordx4 v62, s[64:67], 0 offen offset:0 lds
    v_mfma_f32_32x32x16_bf16 v[192:207], a[228:231], a[8:11], v[192:207]
    ds_read_b64_tr_b16 a[240:241], v10 offset:49152
    ds_read_b64_tr_b16 a[242:243], v10 offset:49664
    buffer_load_dwordx4 v62, s[64:67], s89 offen offset:1024 lds
    v_mul_f32 v248, v51, v128
    v_mul_f32 v128, v50, v128
    v_mfma_f32_32x32x16_bf16 v[208:223], a[228:231], a[120:123], v[208:223]
    s_waitcnt lgkmcnt(2)
    s_barrier
    s_add_u32 m0, s85, 139264
    s_mul_i32 s93, s5, 14
    v_add_u32 v62, s93, v7
    buffer_load_dwordx4 v62, s[64:67], 0 offen offset:0 lds
    v_mfma_f32_32x32x16_bf16 v[160:175], a[232:235], a[12:15], v[160:175]
    ds_read_b64_tr_b16 a[244:245], v11 offset:49152
    ds_read_b64_tr_b16 a[246:247], v11 offset:49664
    buffer_load_dwordx4 v62, s[64:67], s89 offen offset:1024 lds
    ds_read_b64 v[232:233], v56 offset:0
    ds_read_b64 v[234:235], v56 offset:256
    ds_read_b64 v[236:237], v56 offset:512
    v_fmac_f32 v128, v13, v144
    v_mfma_f32_32x32x16_bf16 v[176:191], a[232:235], a[124:127], v[176:191]
    s_add_u32 m0, s85, 16384
    s_mul_i32 s93, s9, 14
    v_add_u32 v62, s93, v7
    buffer_load_dwordx4 v62, s[64:67], 0 offen offset:0 lds
    ds_read_b64 v[238:239], v56 offset:768
    ds_read_b64 v[240:241], v56 offset:1024
    ds_read_b64 v[242:243], v56 offset:1280
    v_mfma_f32_32x32x16_bf16 v[192:207], a[236:239], a[12:15], v[192:207]
    ds_read_b64_tr_b16 a[248:249], v10 offset:53248
    ds_read_b64_tr_b16 a[250:251], v10 offset:53760
    s_waitcnt vmcnt(9)
    buffer_store_dword v59, v32, s[72:75], 0 offen offset:0 sc1
    ds_read_b64 v[244:245], v56 offset:1536
    ds_read_b64 v[246:247], v56 offset:1792
    v_fma_f32 v144, v50, v144, v248
    v_mfma_f32_32x32x16_bf16 v[208:223], a[236:239], a[124:127], v[208:223]
    buffer_load_dwordx4 v62, s[64:67], s89 offen offset:1024 lds
    v_mul_f32 v249, v51, v129
    v_mul_f32 v129, v50, v129
    v_fmac_f32 v129, v13, v145
    s_waitcnt lgkmcnt(10)
    v_mfma_f32_32x32x16_bf16 v[160:175], a[240:243], a[16:19], v[160:175]
    ds_read_b64_tr_b16 a[252:253], v11 offset:53248
    ds_read_b64_tr_b16 a[254:255], v11 offset:53760
    v_fma_f32 v145, v50, v145, v249
    v_mul_f32 v248, v51, v130
    v_mul_f32 v130, v50, v130
    v_fmac_f32 v130, v13, v146
    v_fma_f32 v146, v50, v146, v248
    v_mul_f32 v249, v51, v131
    v_mfma_f32_32x32x16_bf16 v[176:191], a[240:243], a[128:131], v[176:191]
    s_add_u32 m0, s85, 24576
    s_mul_i32 s93, s17, 14
    v_add_u32 v62, s93, v7
    buffer_load_dwordx4 v62, s[64:67], 0 offen offset:0 lds
    v_mov_b32 v52, 0
    v_mov_b32 v53, 0
    v_mov_b32 v229, v59
    v_mov_b32 v231, v59
    v_mfma_f32_32x32x16_bf16 v[192:207], a[244:247], a[16:19], v[192:207]
    ds_read_b64_tr_b16 a[224:225], v10 offset:57344
    ds_read_b64_tr_b16 a[226:227], v10 offset:57856
    v_sub_f32 v224, 0, v43
    v_cmp_eq_u32 vcc, 1, v54
    s_waitcnt lgkmcnt(12)
    v_fmac_f32 v234, v42, v232
    v_fmac_f32 v235, v42, v233
    v_cndmask_b32 v52, v52, v232, vcc
    v_cndmask_b32 v53, v53, v233, vcc
    v_fmac_f32 v234, v224, v233
    v_fmac_f32 v235, v43, v232
    v_mul_f32 v131, v50, v131
    v_mfma_f32_32x32x16_bf16 v[208:223], a[244:247], a[128:131], v[208:223]
    buffer_load_dwordx4 v62, s[64:67], s89 offen offset:1024 lds
    v_cmp_eq_u32 vcc, 2, v54
    s_waitcnt lgkmcnt(11)
    v_fmac_f32 v236, v42, v234
    v_fmac_f32 v237, v42, v235
    v_cndmask_b32 v52, v52, v234, vcc
    v_cndmask_b32 v53, v53, v235, vcc
    v_fmac_f32 v236, v224, v235
    v_fmac_f32 v237, v43, v234
    s_waitcnt lgkmcnt(2)
    v_mfma_f32_32x32x16_bf16 v[160:175], a[248:251], a[20:23], v[160:175]
    ds_read_b64_tr_b16 a[228:229], v11 offset:57344
    ds_read_b64_tr_b16 a[230:231], v11 offset:57856
    v_cmp_eq_u32 vcc, 3, v54
    v_fmac_f32 v238, v42, v236
    v_fmac_f32 v239, v42, v237
    v_cndmask_b32 v52, v52, v236, vcc
    v_cndmask_b32 v53, v53, v237, vcc
    v_fmac_f32 v238, v224, v237
    v_fmac_f32 v239, v43, v236
    v_fmac_f32 v131, v13, v147
    v_mfma_f32_32x32x16_bf16 v[176:191], a[248:251], a[132:135], v[176:191]
    v_cmp_eq_u32 vcc, 4, v54
    v_fmac_f32 v240, v42, v238
    v_fmac_f32 v241, v42, v239
    v_cndmask_b32 v52, v52, v238, vcc
    v_cndmask_b32 v53, v53, v239, vcc
    v_fmac_f32 v240, v224, v239
    v_fmac_f32 v241, v43, v238
    v_cmp_eq_u32 vcc, 5, v54
    v_fmac_f32 v242, v42, v240
    v_fmac_f32 v243, v42, v241
    v_cndmask_b32 v52, v52, v240, vcc
    v_cndmask_b32 v53, v53, v241, vcc
    v_fmac_f32 v242, v224, v241
    v_mfma_f32_32x32x16_bf16 v[192:207], a[252:255], a[20:23], v[192:207]
    ds_read_b64_tr_b16 a[232:233], v10 offset:61440
    ds_read_b64_tr_b16 a[234:235], v10 offset:61952
    v_fmac_f32 v243, v43, v240
    v_cmp_eq_u32 vcc, 6, v54
    v_fmac_f32 v244, v42, v242
    v_fmac_f32 v245, v42, v243
    v_cndmask_b32 v52, v52, v242, vcc
    v_cndmask_b32 v53, v53, v243, vcc
    v_fmac_f32 v244, v224, v243
    v_fmac_f32 v245, v43, v242
    v_fma_f32 v147, v50, v147, v249
    v_mfma_f32_32x32x16_bf16 v[208:223], a[252:255], a[132:135], v[208:223]
    v_cmp_eq_u32 vcc, 7, v54
    v_fmac_f32 v246, v42, v244
    v_fmac_f32 v247, v42, v245
    v_cndmask_b32 v52, v52, v244, vcc
    v_cndmask_b32 v53, v53, v245, vcc
    v_fma_f32 v228, v224, v245, v246
    v_fma_f32 v230, v43, v244, v247
    v_mul_f32 v248, v51, v132
    s_waitcnt lgkmcnt(2)
    v_mfma_f32_32x32x16_bf16 v[160:175], a[224:227], a[24:27], v[160:175]
    ds_read_b64_tr_b16 a[236:237], v11 offset:61440
    ds_read_b64_tr_b16 a[238:239], v11 offset:61952
    buffer_store_dwordx4 v[228:231], v34, s[72:75], 0 offen sc1
    v_mfma_f32_32x32x16_bf16 v[176:191], a[224:227], a[136:139], v[176:191]
    s_barrier
    s_add_u32 m0, s85, 32768
    s_mul_i32 s93, s20, 14
    v_add_u32 v62, s93, v7
    buffer_load_dwordx4 v62, s[64:67], 0 offen offset:0 lds
    v_mul_f32 v132, v50, v132
    v_mfma_f32_32x32x16_bf16 v[192:207], a[228:231], a[24:27], v[192:207]
    v_add_u32 v10, 0xc000, v10
    ds_read_b64_tr_b16 a[240:241], v10 offset:16384
    ds_read_b64_tr_b16 a[242:243], v10 offset:16896
    buffer_load_dwordx4 v62, s[64:67], s89 offen offset:1024 lds
    v_fmac_f32 v132, v13, v148
    v_mfma_f32_32x32x16_bf16 v[208:223], a[228:231], a[136:139], v[208:223]
    s_add_u32 m0, s85, 40960
    s_mul_i32 s93, s21, 14
    v_add_u32 v62, s93, v7
    buffer_load_dwordx4 v62, s[64:67], 0 offen offset:0 lds
    s_waitcnt lgkmcnt(2)
    v_mfma_f32_32x32x16_bf16 v[160:175], a[232:235], a[28:31], v[160:175]
    v_add_u32 v11, 0xc000, v11
    ds_read_b64_tr_b16 a[244:245], v11 offset:16384
    ds_read_b64_tr_b16 a[246:247], v11 offset:16896
    v_fma_f32 v148, v50, v148, v248
    v_mul_f32 v249, v51, v133
    v_mul_f32 v133, v50, v133
    v_fmac_f32 v133, v13, v149
    v_fma_f32 v149, v50, v149, v249
    v_mul_f32 v248, v51, v134
    v_mfma_f32_32x32x16_bf16 v[176:191], a[232:235], a[140:143], v[176:191]
    buffer_load_dwordx4 v62, s[64:67], s89 offen offset:1024 lds
    v_mul_f32 v134, v50, v134
    v_fmac_f32 v134, v13, v150
    v_fma_f32 v150, v50, v150, v248
    v_mul_f32 v249, v51, v135
    v_mfma_f32_32x32x16_bf16 v[192:207], a[236:239], a[28:31], v[192:207]
    ds_read_b64_tr_b16 a[248:249], v10 offset:20480
    ds_read_b64_tr_b16 a[250:251], v10 offset:20992
    v_mul_f32 v135, v50, v135
    v_fmac_f32 v135, v13, v151
    v_fma_f32 v151, v50, v151, v249
    v_mul_f32 v248, v51, v136
    v_mul_f32 v136, v50, v136
    v_fmac_f32 v136, v13, v152
    v_mfma_f32_32x32x16_bf16 v[208:223], a[236:239], a[140:143], v[208:223]
    v_fma_f32 v152, v50, v152, v248
    v_mul_f32 v249, v51, v137
    v_mul_f32 v137, v50, v137
    v_fmac_f32 v137, v13, v153
    v_fma_f32 v153, v50, v153, v249
    v_mul_f32 v248, v51, v138
    v_mul_f32 v138, v50, v138
    v_fmac_f32 v138, v13, v154
    s_waitcnt lgkmcnt(2)
    v_mfma_f32_32x32x16_bf16 v[160:175], a[240:243], a[32:35], v[160:175]
    ds_read_b64_tr_b16 a[252:253], v11 offset:20480
    ds_read_b64_tr_b16 a[254:255], v11 offset:20992
    v_fma_f32 v154, v50, v154, v248
    v_mul_f32 v249, v51, v139
    v_mul_f32 v139, v50, v139
    v_fmac_f32 v139, v13, v155
    v_fma_f32 v155, v50, v155, v249
    v_mul_f32 v248, v51, v140
    v_mfma_f32_32x32x16_bf16 v[176:191], a[240:243], a[144:147], v[176:191]
    v_mul_f32 v140, v50, v140
    v_fmac_f32 v140, v13, v156
    v_fma_f32 v156, v50, v156, v248
    v_mul_f32 v249, v51, v141
    v_mul_f32 v141, v50, v141
    v_fmac_f32 v141, v13, v157
    v_fma_f32 v157, v50, v157, v249
    v_mul_f32 v248, v51, v142
    v_mul_f32 v142, v50, v142
    v_mfma_f32_32x32x16_bf16 v[192:207], a[244:247], a[32:35], v[192:207]
    ds_read_b64_tr_b16 a[224:225], v10 offset:24576
    ds_read_b64_tr_b16 a[226:227], v10 offset:25088
    buffer_load_dword v60, v33, s[72:75], 0 offen offset:0 sc1
    v_fmac_f32 v142, v13, v158
    v_fma_f32 v158, v50, v158, v248
    v_mul_f32 v249, v51, v143
    v_mfma_f32_32x32x16_bf16 v[208:223], a[244:247], a[144:147], v[208:223]
    v_mul_f32 v143, v50, v143
    v_fmac_f32 v143, v13, v159
    v_fma_f32 v159, v50, v159, v249
    s_waitcnt lgkmcnt(2)
    v_mfma_f32_32x32x16_bf16 v[160:175], a[248:251], a[36:39], v[160:175]
    ds_read_b64_tr_b16 a[228:229], v11 offset:24576
    ds_read_b64_tr_b16 a[230:231], v11 offset:25088
    v_mfma_f32_32x32x16_bf16 v[176:191], a[248:251], a[148:151], v[176:191]
    v_mfma_f32_32x32x16_bf16 v[192:207], a[252:255], a[36:39], v[192:207]
    ds_read_b64_tr_b16 a[232:233], v10 offset:28672
    ds_read_b64_tr_b16 a[234:235], v10 offset:29184
    v_mfma_f32_32x32x16_bf16 v[208:223], a[252:255], a[148:151], v[208:223]
    s_waitcnt lgkmcnt(2)
    v_mfma_f32_32x32x16_bf16 v[160:175], a[224:227], a[40:43], v[160:175]
    ds_read_b64_tr_b16 a[236:237], v11 offset:28672
    ds_read_b64_tr_b16 a[238:239], v11 offset:29184
    v_mfma_f32_32x32x16_bf16 v[176:191], a[224:227], a[152:155], v[176:191]
    s_barrier
    s_add_u32 m0, s85, 49152
    s_mul_i32 s93, s90, 14
    v_add_u32 v62, s93, v7
    buffer_load_dwordx4 v62, s[64:67], 0 offen offset:0 lds
    v_mfma_f32_32x32x16_bf16 v[192:207], a[228:231], a[40:43], v[192:207]
    ds_read_b64_tr_b16 a[240:241], v10 offset:32768
    ds_read_b64_tr_b16 a[242:243], v10 offset:33280
    buffer_load_dwordx4 v[232:235], v35, s[72:75], 0 offen sc1
    buffer_load_dwordx4 v[236:239], v36, s[72:75], 0 offen sc1
    buffer_load_dwordx4 v62, s[64:67], s89 offen offset:1024 lds
    v_mfma_f32_32x32x16_bf16 v[208:223], a[228:231], a[152:155], v[208:223]
    s_add_u32 m0, s85, 57344
    s_nop 0
    buffer_load_dwordx4 v8, s[68:71], s91 offen offset:0 lds
    s_waitcnt lgkmcnt(2)
    v_mfma_f32_32x32x16_bf16 v[160:175], a[232:235], a[44:47], v[160:175]
    ds_read_b64_tr_b16 a[244:245], v11 offset:32768
    ds_read_b64_tr_b16 a[246:247], v11 offset:33280
    v_mfma_f32_32x32x16_bf16 v[176:191], a[232:235], a[156:159], v[176:191]
    buffer_load_dwordx4 v9, s[68:71], s91 offen offset:1024 lds
    v_mfma_f32_32x32x16_bf16 v[192:207], a[236:239], a[44:47], v[192:207]
    ds_read_b64_tr_b16 a[248:249], v10 offset:36864
    ds_read_b64_tr_b16 a[250:251], v10 offset:37376
    v_mfma_f32_32x32x16_bf16 v[208:223], a[236:239], a[156:159], v[208:223]
    s_waitcnt lgkmcnt(2)
    v_mfma_f32_32x32x16_bf16 v[160:175], a[240:243], a[48:51], v[160:175]
    ds_read_b64_tr_b16 a[252:253], v11 offset:36864
    ds_read_b64_tr_b16 a[254:255], v11 offset:37376
    v_mfma_f32_32x32x16_bf16 v[176:191], a[240:243], a[160:163], v[176:191]
    v_mfma_f32_32x32x16_bf16 v[192:207], a[244:247], a[48:51], v[192:207]
    ds_read_b64_tr_b16 a[224:225], v10 offset:40960
    ds_read_b64_tr_b16 a[226:227], v10 offset:41472
    v_mfma_f32_32x32x16_bf16 v[208:223], a[244:247], a[160:163], v[208:223]
    s_waitcnt lgkmcnt(2)
    v_mfma_f32_32x32x16_bf16 v[160:175], a[248:251], a[52:55], v[160:175]
    ds_read_b64_tr_b16 a[228:229], v11 offset:40960
    ds_read_b64_tr_b16 a[230:231], v11 offset:41472
    v_mfma_f32_32x32x16_bf16 v[176:191], a[248:251], a[164:167], v[176:191]
    v_mfma_f32_32x32x16_bf16 v[192:207], a[252:255], a[52:55], v[192:207]
    ds_read_b64_tr_b16 a[232:233], v10 offset:45056
    ds_read_b64_tr_b16 a[234:235], v10 offset:45568
    v_mfma_f32_32x32x16_bf16 v[208:223], a[252:255], a[164:167], v[208:223]
    s_waitcnt lgkmcnt(2)
    v_mfma_f32_32x32x16_bf16 v[160:175], a[224:227], a[56:59], v[160:175]
    ds_read_b64_tr_b16 a[236:237], v11 offset:45056
    ds_read_b64_tr_b16 a[238:239], v11 offset:45568
    v_mfma_f32_32x32x16_bf16 v[176:191], a[224:227], a[168:171], v[176:191]
    s_barrier
    s_add_u32 m0, s85, 65536
    s_nop 0
    buffer_load_dwordx4 v8, s[68:71], s39 offen offset:0 lds
    v_mfma_f32_32x32x16_bf16 v[192:207], a[228:231], a[56:59], v[192:207]
    ds_read_b64_tr_b16 a[240:241], v10 offset:49152
    ds_read_b64_tr_b16 a[242:243], v10 offset:49664
    buffer_load_dwordx4 v9, s[68:71], s39 offen offset:1024 lds
    v_mfma_f32_32x32x16_bf16 v[208:223], a[228:231], a[168:171], v[208:223]
    s_add_u32 m0, s85, 73728
    s_nop 0
    buffer_load_dwordx4 v8, s[68:71], s40 offen offset:0 lds
    s_waitcnt lgkmcnt(2)
    v_mfma_f32_32x32x16_bf16 v[160:175], a[232:235], a[60:63], v[160:175]
    ds_read_b64_tr_b16 a[244:245], v11 offset:49152
    ds_read_b64_tr_b16 a[246:247], v11 offset:49664
    s_waitcnt vmcnt(9)
    v_cmp_ne_u32 vcc, v60, v59
    s_cbranch_vccnz SLOW_F0
BACK_F0:
    v_mfma_f32_32x32x16_bf16 v[176:191], a[232:235], a[172:175], v[176:191]
    s_add_u32 s94, s4, 0
    buffer_load_dwordx4 a[0:3], v30, s[72:75], s94 offen offset:0 sc1
    v_mfma_f32_32x32x16_bf16 v[192:207], a[236:239], a[60:63], v[192:207]
    ds_read_b64_tr_b16 a[248:249], v10 offset:53248
    ds_read_b64_tr_b16 a[250:251], v10 offset:53760
    v_mfma_f32_32x32x16_bf16 v[208:223], a[236:239], a[172:175], v[208:223]
    buffer_load_dwordx4 a[112:115], v30, s[72:75], s94 offen offset:1024 sc1
    s_waitcnt lgkmcnt(2)
    v_mfma_f32_32x32x16_bf16 v[160:175], a[240:243], a[64:67], v[160:175]
    ds_read_b64_tr_b16 a[252:253], v11 offset:53248
    ds_read_b64_tr_b16 a[254:255], v11 offset:53760
    v_mfma_f32_32x32x16_bf16 v[176:191], a[240:243], a[176:179], v[176:191]
    buffer_load_dwordx4 a[4:7], v30, s[72:75], s94 offen offset:2048 sc1
    v_mfma_f32_32x32x16_bf16 v[192:207], a[244:247], a[64:67], v[192:207]
    ds_read_b64_tr_b16 a[224:225], v10 offset:57344
    ds_read_b64_tr_b16 a[226:227], v10 offset:57856
    v_mfma_f32_32x32x16_bf16 v[208:223], a[244:247], a[176:179], v[208:223]
    buffer_load_dwordx4 a[116:119], v30, s[72:75], s94 offen offset:3072 sc1
    s_waitcnt lgkmcnt(2)
    v_mfma_f32_32x32x16_bf16 v[160:175], a[248:251], a[68:71], v[160:175]
    ds_read_b64_tr_b16 a[228:229], v11 offset:57344
    ds_read_b64_tr_b16 a[230:231], v11 offset:57856
    v_mfma_f32_32x32x16_bf16 v[176:191], a[248:251], a[180:183], v[176:191]
    s_add_u32 s94, s5, 0
    buffer_load_dwordx4 a[8:11], v30, s[72:75], s94 offen offset:0 sc1
    v_mfma_f32_32x32x16_bf16 v[192:207], a[252:255], a[68:71], v[192:207]
    ds_read_b64_tr_b16 a[232:233], v10 offset:61440
    ds_read_b64_tr_b16 a[234:235], v10 offset:61952
    s_waitcnt vmcnt(12)
    v_xor_b32 v224, v233, v37
    v_xor_b32 v225, v235, v37
    s_waitcnt vmcnt(11)
    v_xor_b32 v226, v237, v38
    v_xor_b32 v227, v239, v38
    v_or3_b32 v224, v224, v225, v226
    v_or_b32 v224, v224, v227
    v_cmp_ne_u32 vcc, 0, v224
    s_cbranch_vccnz SLOW_S
BACK_S:
    v_fma_f32 v232, v44, v236, v232
    v_mfma_f32_32x32x16_bf16 v[208:223], a[252:255], a[180:183], v[208:223]
    buffer_load_dwordx4 a[120:123], v30, s[72:75], s94 offen offset:1024 sc1
    v_fma_f32 v234, v44, v238, v234
    v_fma_f32 v232, -v45, v238, v232
    v_fmac_f32 v234, v45, v236
    v_mul_f32 v224, v48, v232
    v_mul_f32 v225, v48, v234
    v_fma_f32 v224, -v49, v234, v224
    s_waitcnt lgkmcnt(2)
    v_mfma_f32_32x32x16_bf16 v[160:175], a[224:227], a[72:75], v[160:175]
    ds_read_b64_tr_b16 a[236:237], v11 offset:61440
    ds_read_b64_tr_b16 a[238:239], v11 offset:61952
    v_fmac_f32 v225, v49, v232
    ds_write_b64 v55, v[224:225] offset:2048
    v_mfma_f32_32x32x16_bf16 v[176:191], a[224:227], a[184:187], v[176:191]
    s_barrier
    buffer_load_dwordx4 a[12:15], v30, s[72:75], s94 offen offset:2048 sc1
    v_mfma_f32_32x32x16_bf16 v[192:207], a[228:231], a[72:75], v[192:207]
    v_add_u32 v10, 0xc000, v10
    ds_read_b64_tr_b16 a[240:241], v10 offset:49152
    ds_read_b64_tr_b16 a[242:243], v10 offset:49664
    v_mfma_f32_32x32x16_bf16 v[208:223], a[228:231], a[184:187], v[208:223]
    s_waitcnt lgkmcnt(2)
    s_barrier
    buffer_load_dwordx4 a[124:127], v30, s[72:75], s94 offen offset:3072 sc1
    ds_read_b64 v[232:233], v56 offset:2048
    ds_read_b64 v[234:235], v56 offset:2304
    v_mfma_f32_32x32x16_bf16 v[160:175], a[232:235], a[76:79], v[160:175]
    v_add_u32 v11, 0xc000, v11
    ds_read_b64_tr_b16 a[244:245], v11 offset:49152
    ds_read_b64_tr_b16 a[246:247], v11 offset:49664
    s_add_u32 s94, s9, 0
    buffer_load_dwordx4 a[16:19], v30, s[72:75], s94 offen offset:0 sc1
    ds_read_b64 v[236:237], v56 offset:2560
    ds_read_b64 v[238:239], v56 offset:2816
    v_mfma_f32_32x32x16_bf16 v[176:191], a[232:235], a[188:191], v[176:191]
    buffer_load_dwordx4 a[128:131], v30, s[72:75], s94 offen offset:1024 sc1
    ds_read_b64 v[240:241], v56 offset:3072
    ds_read_b64 v[242:243], v56 offset:3328
    ds_read_b64 v[244:245], v56 offset:3584
    ds_read_b64 v[246:247], v56 offset:3840
    v_mfma_f32_32x32x16_bf16 v[192:207], a[236:239], a[76:79], v[192:207]
    ds_read_b64_tr_b16 a[248:249], v10 offset:53248
    ds_read_b64_tr_b16 a[250:251], v10 offset:53760
    v_mfma_f32_32x32x16_bf16 v[208:223], a[236:239], a[188:191], v[208:223]
    buffer_load_dwordx4 a[20:23], v30, s[72:75], s94 offen offset:2048 sc1
    s_waitcnt lgkmcnt(8)
    v_mfma_f32_32x32x16_bf16 v[160:175], a[240:243], a[80:83], v[160:175]
    ds_read_b64_tr_b16 a[252:253], v11 offset:53248
    ds_read_b64_tr_b16 a[254:255], v11 offset:53760
    v_mfma_f32_32x32x16_bf16 v[176:191], a[240:243], a[192:195], v[176:191]
    buffer_load_dwordx4 a[132:135], v30, s[72:75], s94 offen offset:3072 sc1
    v_mfma_f32_32x32x16_bf16 v[192:207], a[244:247], a[80:83], v[192:207]
    ds_read_b64_tr_b16 a[224:225], v10 offset:57344
    ds_read_b64_tr_b16 a[226:227], v10 offset:57856
    v_add_f32 v232, v232, v234
    v_add_f32 v233, v233, v235
    s_waitcnt lgkmcnt(10)
    v_add_f32 v236, v236, v238
    v_add_f32 v237, v237, v239
    s_waitcnt lgkmcnt(8)
    v_add_f32 v240, v240, v242
    v_add_f32 v241, v241, v243
    s_waitcnt lgkmcnt(6)
    v_add_f32 v244, v244, v246
    v_add_f32 v245, v245, v247
    v_add_f32 v232, v232, v236
    v_add_f32 v233, v233, v237
    v_mfma_f32_32x32x16_bf16 v[208:223], a[244:247], a[192:195], v[208:223]
    s_add_u32 s94, s17, 0
    buffer_load_dwordx4 a[24:27], v30, s[72:75], s94 offen offset:0 sc1
    v_add_f32 v240, v240, v244
    v_add_f32 v241, v241, v245
    v_add_f32 v232, v232, v240
    v_add_f32 v233, v233, v241
    v_fma_f32 v52, v46, v232, v52
    s_waitcnt lgkmcnt(2)
    v_mfma_f32_32x32x16_bf16 v[160:175], a[248:251], a[84:87], v[160:175]
    ds_read_b64_tr_b16 a[228:229], v11 offset:57344
    ds_read_b64_tr_b16 a[230:231], v11 offset:57856
    buffer_load_dwordx4 a[136:139], v30, s[72:75], s94 offen offset:1024 sc1
    v_fma_f32 v53, v46, v233, v53
    v_fma_f32 v52, -v47, v233, v52
    v_fmac_f32 v53, v47, v232
    v_mul_f32 v224, v50, v52
    v_mfma_f32_32x32x16_bf16 v[176:191], a[248:251], a[196:199], v[176:191]
    buffer_load_dwordx4 a[28:31], v30, s[72:75], s94 offen offset:2048 sc1
    v_mul_f32 v225, v50, v53
    v_fmac_f32 v224, v13, v53
    v_fmac_f32 v225, v51, v52
    v_fmac_f32 v128, v40, v224
    v_fmac_f32 v144, v40, v225
    v_fmac_f32 v128, v12, v225
    v_fmac_f32 v144, v41, v224
    v_fmac_f32 v129, v40, v128
    v_mfma_f32_32x32x16_bf16 v[192:207], a[252:255], a[84:87], v[192:207]
    ds_read_b64_tr_b16 a[232:233], v10 offset:61440
    ds_read_b64_tr_b16 a[234:235], v10 offset:61952
    v_fmac_f32 v145, v40, v144
    v_fmac_f32 v129, v12, v144
    v_fmac_f32 v145, v41, v128
    v_cvt_pk_bf16_f32 v232, v128, v129
    v_cvt_pk_bf16_f32 v240, -v144, -v145
    v_fmac_f32 v130, v40, v129
    v_fmac_f32 v146, v40, v145
    v_fmac_f32 v130, v12, v145
    v_fmac_f32 v146, v41, v129
    v_mfma_f32_32x32x16_bf16 v[208:223], a[252:255], a[196:199], v[208:223]
    buffer_load_dwordx4 a[140:143], v30, s[72:75], s94 offen offset:3072 sc1
    v_fmac_f32 v131, v40, v130
    v_fmac_f32 v147, v40, v146
    v_fmac_f32 v131, v12, v146
    v_fmac_f32 v147, v41, v130
    v_cvt_pk_bf16_f32 v233, v130, v131
    v_cvt_pk_bf16_f32 v241, -v146, -v147
    s_waitcnt lgkmcnt(2)
    v_mfma_f32_32x32x16_bf16 v[160:175], a[224:227], a[88:91], v[160:175]
    ds_read_b64_tr_b16 a[236:237], v11 offset:61440
    ds_read_b64_tr_b16 a[238:239], v11 offset:61952
    s_add_u32 s94, s20, 0
    buffer_load_dwordx4 a[32:35], v30, s[72:75], s94 offen offset:0 sc1
    v_fmac_f32 v132, v40, v131
    v_fmac_f32 v148, v40, v147
    v_fmac_f32 v132, v12, v147
    v_fmac_f32 v148, v41, v131
    v_mfma_f32_32x32x16_bf16 v[176:191], a[224:227], a[200:203], v[176:191]
    s_barrier
    buffer_load_dwordx4 a[144:147], v30, s[72:75], s94 offen offset:1024 sc1
    v_fmac_f32 v133, v40, v132
    v_fmac_f32 v149, v40, v148
    v_fmac_f32 v133, v12, v148
    v_fmac_f32 v149, v41, v132
    v_mfma_f32_32x32x16_bf16 v[192:207], a[228:231], a[88:91], v[192:207]
    ds_read_b64_tr_b16 a[240:241], v10 offset:16384
    ds_read_b64_tr_b16 a[242:243], v10 offset:16896
    v_cvt_pk_bf16_f32 v234, v132, v133
    v_cvt_pk_bf16_f32 v242, -v148, -v149
    v_fmac_f32 v134, v40, v133
    v_fmac_f32 v150, v40, v149
    v_fmac_f32 v134, v12, v149
    v_fmac_f32 v150, v41, v133
    v_fmac_f32 v135, v40, v134
    v_fmac_f32 v151, v40, v150
    v_fmac_f32 v135, v12, v150
    v_mfma_f32_32x32x16_bf16 v[208:223], a[228:231], a[200:203], v[208:223]
    buffer_load_dwordx4 a[36:39], v30, s[72:75], s94 offen offset:2048 sc1
    v_fmac_f32 v151, v41, v134
    v_cvt_pk_bf16_f32 v235, v134, v135
    v_cvt_pk_bf16_f32 v243, -v150, -v151
    v_fmac_f32 v136, v40, v135
    v_fmac_f32 v152, v40, v151
    v_fmac_f32 v136, v12, v151
    s_waitcnt lgkmcnt(2)
    v_mfma_f32_32x32x16_bf16 v[160:175], a[232:235], a[92:95], v[160:175]
    ds_read_b64_tr_b16 a[244:245], v11 offset:16384
    ds_read_b64_tr_b16 a[246:247], v11 offset:16896
    buffer_load_dwordx4 a[148:151], v30, s[72:75], s94 offen offset:3072 sc1
    v_fmac_f32 v152, v41, v135
    v_fmac_f32 v137, v40, v136
    v_fmac_f32 v153, v40, v152
    v_fmac_f32 v137, v12, v152
    v_fmac_f32 v153, v41, v136
    v_mfma_f32_32x32x16_bf16 v[176:191], a[232:235], a[204:207], v[176:191]
    s_add_u32 s94, s21, 0
    buffer_load_dwordx4 a[40:43], v30, s[72:75], s94 offen offset:0 sc1
    v_cvt_pk_bf16_f32 v236, v136, v137
    v_cvt_pk_bf16_f32 v244, -v152, -v153
    v_fmac_f32 v138, v40, v137
    v_fmac_f32 v154, v40, v153
    v_fmac_f32 v138, v12, v153
    v_fmac_f32 v154, v41, v137
    v_mfma_f32_32x32x16_bf16 v[192:207], a[236:239], a[92:95], v[192:207]
    ds_read_b64_tr_b16 a[248:249], v10 offset:20480
    ds_read_b64_tr_b16 a[250:251], v10 offset:20992
    buffer_load_dwordx4 a[152:155], v30, s[72:75], s94 offen offset:1024 sc1
    v_fmac_f32 v139, v40, v138
    v_fmac_f32 v155, v40, v154
    v_fmac_f32 v139, v12, v154
    v_fmac_f32 v155, v41, v138
    v_mfma_f32_32x32x16_bf16 v[208:223], a[236:239], a[204:207], v[208:223]
    buffer_load_dwordx4 a[44:47], v30, s[72:75], s94 offen offset:2048 sc1
    v_cvt_pk_bf16_f32 v237, v138, v139
    v_cvt_pk_bf16_f32 v245, -v154, -v155
    v_fmac_f32 v140, v40, v139
    v_fmac_f32 v156, v40, v155
    v_fmac_f32 v140, v12, v155
    v_fmac_f32 v156, v41, v139
    s_waitcnt lgkmcnt(2)
    v_mfma_f32_32x32x16_bf16 v[160:175], a[240:243], a[96:99], v[160:175]
    ds_read_b64_tr_b16 a[252:253], v11 offset:20480
    ds_read_b64_tr_b16 a[254:255], v11 offset:20992
    v_fmac_f32 v141, v40, v140
    v_fmac_f32 v157, v40, v156
    v_fmac_f32 v141, v12, v156
    v_fmac_f32 v157, v41, v140
    v_cvt_pk_bf16_f32 v238, v140, v141
    v_cvt_pk_bf16_f32 v246, -v156, -v157
    v_fmac_f32 v142, v40, v141
    v_fmac_f32 v158, v40, v157
    v_fmac_f32 v142, v12, v157
    v_mfma_f32_32x32x16_bf16 v[176:191], a[240:243], a[208:211], v[176:191]
    buffer_load_dwordx4 a[156:159], v30, s[72:75], s94 offen offset:3072 sc1
    v_fmac_f32 v158, v41, v141
    v_fmac_f32 v143, v40, v142
    v_fmac_f32 v159, v40, v158
    v_fmac_f32 v143, v12, v158
    v_fmac_f32 v159, v41, v142
    v_cvt_pk_bf16_f32 v239, v142, v143
    v_cvt_pk_bf16_f32 v247, -v158, -v159
    v_mfma_f32_32x32x16_bf16 v[192:207], a[244:247], a[96:99], v[192:207]
    ds_read_b64_tr_b16 a[224:225], v10 offset:24576
    ds_read_b64_tr_b16 a[226:227], v10 offset:25088
    s_add_u32 s94, s90, 0
    buffer_load_dwordx4 a[48:51], v30, s[72:75], s94 offen offset:0 sc1
    v_xor_b32 v230, 16, v57
    v_xor_b32 v231, 32, v58
    v_mfma_f32_32x32x16_bf16 v[208:223], a[244:247], a[208:211], v[208:223]
    buffer_load_dwordx4 a[160:163], v30, s[72:75], s94 offen offset:1024 sc1
    ds_write_b128 v57, v[232:235] offset:8192
    s_waitcnt lgkmcnt(3)
    v_mfma_f32_32x32x16_bf16 v[160:175], a[248:251], a[100:103], v[160:175]
    ds_read_b64_tr_b16 a[228:229], v11 offset:24576
    ds_read_b64_tr_b16 a[230:231], v11 offset:25088
    ds_write_b128 v230, v[236:239] offset:8192
    ds_read_b64_tr_b16 v[128:129], v58 offset:8192
    ds_read_b64_tr_b16 v[130:131], v231 offset:8448
    ds_read_b64_tr_b16 v[132:133], v58 offset:9216
    ds_read_b64_tr_b16 v[134:135], v231 offset:9472
    v_mfma_f32_32x32x16_bf16 v[176:191], a[248:251], a[212:215], v[176:191]
    buffer_load_dwordx4 v9, s[68:71], s40 offen offset:1024 lds
    ds_write_b128 v57, v[240:243] offset:8192
    v_mfma_f32_32x32x16_bf16 v[192:207], a[252:255], a[100:103], v[192:207]
    ds_read_b64_tr_b16 a[232:233], v10 offset:28672
    ds_read_b64_tr_b16 a[234:235], v10 offset:29184
    s_add_u32 m0, s85, 81920
    s_nop 0
    buffer_load_dwordx4 v8, s[68:71], s10 offen offset:0 lds
    v_mfma_f32_32x32x16_bf16 v[208:223], a[252:255], a[212:215], v[208:223]
    buffer_load_dwordx4 v9, s[68:71], s10 offen offset:1024 lds
    ds_write_b128 v230, v[244:247] offset:8192
    ds_read_b64_tr_b16 v[136:137], v58 offset:8192
    ds_read_b64_tr_b16 v[138:139], v231 offset:8448
    s_waitcnt lgkmcnt(11)
    v_mfma_f32_32x32x16_bf16 v[160:175], a[224:227], a[104:107], v[160:175]
    ds_read_b64_tr_b16 a[236:237], v11 offset:28672
    ds_read_b64_tr_b16 a[238:239], v11 offset:29184
    s_add_u32 m0, s85, 90112
    s_nop 0
    buffer_load_dwordx4 v8, s[12:15], s91 offen offset:0 lds
    ds_read_b64_tr_b16 v[140:141], v58 offset:9216
    ds_read_b64_tr_b16 v[142:143], v231 offset:9472
    v_mfma_f32_32x32x16_bf16 v[176:191], a[224:227], a[216:219], v[176:191]
    s_waitcnt vmcnt(35)
    s_barrier
    buffer_load_dwordx4 v9, s[12:15], s91 offen offset:1024 lds
    v_mfma_f32_32x32x16_bf16 v[192:207], a[228:231], a[104:107], v[192:207]
    v_add_u32 v26, 0x18000, v26
    ds_read_b64_tr_b16 a[248:249], v26 offset:32768
    ds_read_b64_tr_b16 a[250:251], v26 offset:33280
    v_add_u32 v27, 0x18000, v27
    ds_read_b64_tr_b16 a[252:253], v27 offset:32768
    ds_read_b64_tr_b16 a[254:255], v27 offset:33280
    v_mfma_f32_32x32x16_bf16 v[208:223], a[228:231], a[216:219], v[208:223]
    s_add_u32 m0, s85, 98304
    s_nop 0
    buffer_load_dwordx4 v8, s[12:15], s39 offen offset:0 lds
    s_waitcnt lgkmcnt(6)
    v_mfma_f32_32x32x16_bf16 v[160:175], a[232:235], a[108:111], v[160:175]
    ds_read_b64_tr_b16 a[224:225], v26 offset:34816
    ds_read_b64_tr_b16 a[226:227], v26 offset:35328
    ds_read_b64_tr_b16 a[228:229], v27 offset:34816
    ds_read_b64_tr_b16 a[230:231], v27 offset:35328
    v_mfma_f32_32x32x16_bf16 v[176:191], a[232:235], a[220:223], v[176:191]
    buffer_load_dwordx4 v9, s[12:15], s39 offen offset:1024 lds
    v_mfma_f32_32x32x16_bf16 v[192:207], a[236:239], a[108:111], v[192:207]
    ds_read_b64_tr_b16 a[232:233], v26 offset:36864
    ds_read_b64_tr_b16 a[234:235], v26 offset:37376
    v_mfma_f32_32x32x16_bf16 v[208:223], a[236:239], a[220:223], v[208:223]
    ds_read_b64_tr_b16 a[236:237], v27 offset:36864
    ds_read_b64_tr_b16 a[238:239], v27 offset:37376
    buffer_store_dwordx4 v[128:131], v29, s[72:75], 0 offen offset:0 sc1
    buffer_store_dwordx4 v[132:135], v29, s[72:75], 0 offen offset:1024 sc1
    buffer_store_dwordx4 v[136:139], v29, s[72:75], s38 offen offset:0 sc1
    s_waitcnt lgkmcnt(12)
    buffer_store_dwordx4 v[140:143], v29, s[72:75], s38 offen offset:1024 sc1
    s_waitcnt vmcnt(35) lgkmcnt(4)
    v_mfma_f32_32x32x16_bf16 v[96:111], a[248:251], a[0:3], 0
    ds_read_b64_tr_b16 a[240:241], v26 offset:38912
    ds_read_b64_tr_b16 a[242:243], v26 offset:39424
    ds_read_b64_tr_b16 a[244:245], v27 offset:38912
    ds_read_b64_tr_b16 a[246:247], v27 offset:39424
    v_add_u32 v28, 0x1000, v28
    v_mul_f32 v160, s92, v160
    v_mul_f32 v161, s92, v161
    v_mul_f32 v162, s92, v162
    v_mul_f32 v163, s92, v163
    v_exp_f32 v160, v160
    v_exp_f32 v161, v161
    v_exp_f32 v162, v162
    v_exp_f32 v163, v163
    v_add_f32 v160, 1.0, v160
    v_add_f32 v161, 1.0, v161
    v_add_f32 v162, 1.0, v162
    v_add_f32 v163, 1.0, v163
    v_rcp_f32 v160, v160
    v_rcp_f32 v161, v161
    v_rcp_f32 v162, v162
    v_rcp_f32 v163, v163
    v_mul_f32 v160, v160, v168
    v_mfma_f32_32x32x16_bf16 v[112:127], a[252:255], a[0:3], 0
    v_mul_f32 v161, v161, v169
    v_mul_f32 v162, v162, v170
    v_mul_f32 v163, v163, v171
    v_cvt_pk_bf16_f32 v160, v160, v161
    v_cvt_pk_bf16_f32 v161, v162, v163
    v_mul_f32 v164, s92, v164
    v_mul_f32 v165, s92, v165
    v_mul_f32 v166, s92, v166
    v_mul_f32 v167, s92, v167
    v_exp_f32 v164, v164
    v_exp_f32 v165, v165
    v_exp_f32 v166, v166
    v_exp_f32 v167, v167
    v_add_f32 v164, 1.0, v164
    v_add_f32 v165, 1.0, v165
    v_add_f32 v166, 1.0, v166
    v_add_f32 v167, 1.0, v167
    v_rcp_f32 v164, v164
    v_rcp_f32 v165, v165
    v_rcp_f32 v166, v166
    v_rcp_f32 v167, v167
    v_mul_f32 v164, v164, v172
    v_mul_f32 v165, v165, v173
    v_mul_f32 v166, v166, v174
    v_mfma_f32_32x32x16_bf16 v[96:111], a[224:227], a[112:115], v[96:111]
    ds_read_b64_tr_b16 a[248:249], v26 offset:40960
    ds_read_b64_tr_b16 a[250:251], v26 offset:41472
    ds_read_b64_tr_b16 a[252:253], v27 offset:40960
    ds_read_b64_tr_b16 a[254:255], v27 offset:41472
    s_add_u32 m0, s85, 106496
    s_nop 0
    buffer_load_dwordx4 v8, s[12:15], s40 offen offset:0 lds
    v_mul_f32 v167, v167, v175
    v_cvt_pk_bf16_f32 v162, v164, v165
    v_cvt_pk_bf16_f32 v163, v166, v167
    v_mul_f32 v176, s92, v176
    v_mul_f32 v177, s92, v177
    v_mul_f32 v178, s92, v178
    v_mul_f32 v179, s92, v179
    v_exp_f32 v176, v176
    v_exp_f32 v177, v177
    v_exp_f32 v178, v178
    v_exp_f32 v179, v179
    v_add_f32 v176, 1.0, v176
    v_add_f32 v177, 1.0, v177
    v_add_f32 v178, 1.0, v178
    v_add_f32 v179, 1.0, v179
    v_mfma_f32_32x32x16_bf16 v[112:127], a[228:231], a[112:115], v[112:127]
    buffer_load_dwordx4 v9, s[12:15], s40 offen offset:1024 lds
    v_rcp_f32 v176, v176
    v_rcp_f32 v177, v177
    v_rcp_f32 v178, v178
    v_rcp_f32 v179, v179
    v_mul_f32 v176, v176, v184
    v_mul_f32 v177, v177, v185
    v_mul_f32 v178, v178, v186
    v_mul_f32 v179, v179, v187
    v_cvt_pk_bf16_f32 v176, v176, v177
    v_cvt_pk_bf16_f32 v177, v178, v179
    v_mul_f32 v180, s92, v180
    v_mul_f32 v181, s92, v181
    v_mul_f32 v182, s92, v182
    v_mul_f32 v183, s92, v183
    v_exp_f32 v180, v180
    v_exp_f32 v181, v181
    v_exp_f32 v182, v182
    v_exp_f32 v183, v183
    s_waitcnt vmcnt(35) lgkmcnt(4)
    v_mfma_f32_32x32x16_bf16 v[96:111], a[232:235], a[4:7], v[96:111]
    ds_read_b64_tr_b16 a[224:225], v26 offset:43008
    ds_read_b64_tr_b16 a[226:227], v26 offset:43520
    ds_read_b64_tr_b16 a[228:229], v27 offset:43008
    ds_read_b64_tr_b16 a[230:231], v27 offset:43520
    s_add_u32 m0, s85, 147456
    s_nop 0
    buffer_load_dwordx4 v8, s[12:15], s10 offen offset:0 lds
    v_add_f32 v180, 1.0, v180
    v_add_f32 v181, 1.0, v181
    v_add_f32 v182, 1.0, v182
    v_add_f32 v183, 1.0, v183
    v_rcp_f32 v180, v180
    v_rcp_f32 v181, v181
    v_rcp_f32 v182, v182
    v_rcp_f32 v183, v183
    v_mul_f32 v180, v180, v188
    v_mul_f32 v181, v181, v189
    v_mul_f32 v182, v182, v190
    v_mul_f32 v183, v183, v191
    v_cvt_pk_bf16_f32 v178, v180, v181
    v_cvt_pk_bf16_f32 v179, v182, v183
    v_mul_f32 v192, s92, v192
    v_mfma_f32_32x32x16_bf16 v[112:127], a[236:239], a[4:7], v[112:127]
    buffer_load_dwordx4 v9, s[12:15], s10 offen offset:1024 lds
    v_mul_f32 v193, s92, v193
    v_mul_f32 v194, s92, v194
    v_mul_f32 v195, s92, v195
    v_exp_f32 v192, v192
    v_exp_f32 v193, v193
    v_exp_f32 v194, v194
    v_exp_f32 v195, v195
    v_add_f32 v192, 1.0, v192
    v_add_f32 v193, 1.0, v193
    v_add_f32 v194, 1.0, v194
    v_add_f32 v195, 1.0, v195
    v_rcp_f32 v192, v192
    v_rcp_f32 v193, v193
    v_rcp_f32 v194, v194
    v_rcp_f32 v195, v195
    v_mul_f32 v192, v192, v200
    v_mul_f32 v193, v193, v201
    v_mul_f32 v194, v194, v202
    v_mul_f32 v195, v195, v203
    v_mfma_f32_32x32x16_bf16 v[96:111], a[240:243], a[116:119], v[96:111]
    ds_read_b64_tr_b16 a[232:233], v26 offset:45056
    ds_read_b64_tr_b16 a[234:235], v26 offset:45568
    ds_read_b64_tr_b16 a[236:237], v27 offset:45056
    ds_read_b64_tr_b16 a[238:239], v27 offset:45568
    buffer_load_dwordx4 a[52:55], v30, s[72:75], s94 offen offset:2048 sc1
    v_cvt_pk_bf16_f32 v192, v192, v193
    v_cvt_pk_bf16_f32 v193, v194, v195
    v_mul_f32 v196, s92, v196
    v_mul_f32 v197, s92, v197
    v_mul_f32 v198, s92, v198
    v_mul_f32 v199, s92, v199
    v_exp_f32 v196, v196
    v_exp_f32 v197, v197
    v_exp_f32 v198, v198
    v_exp_f32 v199, v199
    v_add_f32 v196, 1.0, v196
    v_add_f32 v197, 1.0, v197
    v_add_f32 v198, 1.0, v198
    v_add_f32 v199, 1.0, v199
    v_rcp_f32 v196, v196
    v_mfma_f32_32x32x16_bf16 v[112:127], a[244:247], a[116:119], v[112:127]
    buffer_load_dwordx4 a[164:167], v30, s[72:75], s94 offen offset:3072 sc1
    v_rcp_f32 v197, v197
    v_rcp_f32 v198, v198
    v_rcp_f32 v199, v199
    v_mul_f32 v196, v196, v204
    v_mul_f32 v197, v197, v205
    v_mul_f32 v198, v198, v206
    v_mul_f32 v199, v199, v207
    v_cvt_pk_bf16_f32 v194, v196, v197
    v_cvt_pk_bf16_f32 v195, v198, v199
    v_mul_f32 v208, s92, v208
    v_mul_f32 v209, s92, v209
    v_mul_f32 v210, s92, v210
    v_mul_f32 v211, s92, v211
    v_exp_f32 v208, v208
    v_exp_f32 v209, v209
    v_exp_f32 v210, v210
    v_exp_f32 v211, v211
    v_add_f32 v208, 1.0, v208
    v_add_f32 v209, 1.0, v209
    s_waitcnt vmcnt(37) lgkmcnt(4)
    v_mfma_f32_32x32x16_bf16 v[96:111], a[248:251], a[8:11], v[96:111]
    ds_read_b64_tr_b16 a[240:241], v26 offset:47104
    ds_read_b64_tr_b16 a[242:243], v26 offset:47616
    ds_read_b64_tr_b16 a[244:245], v27 offset:47104
    ds_read_b64_tr_b16 a[246:247], v27 offset:47616
    s_waitcnt vmcnt(6)
    buffer_store_dword v59, v32, s[72:75], 0 offen offset:256 sc1
    s_add_u32 m0, s85, 155648
    v_add_u32 v7, 57344, v7
    s_mul_i32 s93, s4, 14
    v_add_u32 v62, s93, v7
    buffer_load_dwordx4 v62, s[64:67], 0 offen offset:0 lds
    v_add_f32 v210, 1.0, v210
    v_add_f32 v211, 1.0, v211
    v_rcp_f32 v208, v208
    v_rcp_f32 v209, v209
    v_rcp_f32 v210, v210
    v_rcp_f32 v211, v211
    v_mul_f32 v208, v208, v216
    v_mul_f32 v209, v209, v217
    v_mul_f32 v210, v210, v218
    v_mul_f32 v211, v211, v219
    v_mfma_f32_32x32x16_bf16 v[112:127], a[252:255], a[8:11], v[112:127]
    s_barrier
    buffer_load_dwordx4 v62, s[64:67], s89 offen offset:1024 lds
    v_cvt_pk_bf16_f32 v208, v208, v209
    v_cvt_pk_bf16_f32 v209, v210, v211
    v_mul_f32 v212, s92, v212
    v_mul_f32 v213, s92, v213
    v_mul_f32 v214, s92, v214
    v_mul_f32 v215, s92, v215
    v_exp_f32 v212, v212
    v_exp_f32 v213, v213
    v_exp_f32 v214, v214
    v_exp_f32 v215, v215
    v_add_f32 v212, 1.0, v212
    v_add_f32 v213, 1.0, v213
    v_add_f32 v214, 1.0, v214
    v_add_f32 v215, 1.0, v215
    v_rcp_f32 v212, v212
    v_rcp_f32 v213, v213
    v_rcp_f32 v214, v214
    v_mfma_f32_32x32x16_bf16 v[96:111], a[224:227], a[120:123], v[96:111]
    v_subrev_u32 v26, 0x18000, v26
    ds_read_b64_tr_b16 a[248:249], v26 offset:16384
    ds_read_b64_tr_b16 a[250:251], v26 offset:16896
    v_subrev_u32 v27, 0x18000, v27
    ds_read_b64_tr_b16 a[252:253], v27 offset:16384
    ds_read_b64_tr_b16 a[254:255], v27 offset:16896
    s_add_u32 m0, s85, 114688
    s_mul_i32 s93, s5, 14
    v_add_u32 v62, s93, v7
    buffer_load_dwordx4 v62, s[64:67], 0 offen offset:0 lds
    v_rcp_f32 v215, v215
    v_mul_f32 v212, v212, v220
    v_mul_f32 v213, v213, v221
    v_mul_f32 v214, v214, v222
    v_mul_f32 v215, v215, v223
    v_cvt_pk_bf16_f32 v210, v212, v213
    v_cvt_pk_bf16_f32 v211, v214, v215
    v_mfma_f32_32x32x16_bf16 v[112:127], a[228:231], a[120:123], v[112:127]
    buffer_load_dwordx4 v62, s[64:67], s89 offen offset:1024 lds
    s_waitcnt lgkmcnt(4)
    v_mfma_f32_32x32x16_bf16 v[96:111], a[232:235], a[12:15], v[96:111]
    ds_read_b64_tr_b16 a[224:225], v26 offset:18432
    ds_read_b64_tr_b16 a[226:227], v26 offset:18944
    ds_read_b64_tr_b16 a[228:229], v27 offset:18432
    ds_read_b64_tr_b16 a[230:231], v27 offset:18944
    buffer_store_dwordx4 v[160:163], v28, s[72:75], s36 offen offset:0 sc1
    buffer_store_dwordx4 v[176:179], v28, s[72:75], s37 offen offset:0 sc1
    buffer_store_dwordx4 v[192:195], v28, s[72:75], s36 offen offset:1024 sc1
    buffer_store_dwordx4 v[208:211], v28, s[72:75], s37 offen offset:1024 sc1
    v_mfma_f32_32x32x16_bf16 v[112:127], a[236:239], a[12:15], v[112:127]
    v_mfma_f32_32x32x16_bf16 v[96:111], a[240:243], a[124:127], v[96:111]
    ds_read_b64_tr_b16 a[232:233], v26 offset:20480
    ds_read_b64_tr_b16 a[234:235], v26 offset:20992
    ds_read_b64_tr_b16 a[236:237], v27 offset:20480
    ds_read_b64_tr_b16 a[238:239], v27 offset:20992
    v_mfma_f32_32x32x16_bf16 v[112:127], a[244:247], a[124:127], v[112:127]
    s_waitcnt lgkmcnt(4)
    v_mfma_f32_32x32x16_bf16 v[96:111], a[248:251], a[16:19], v[96:111]
    ds_read_b64_tr_b16 a[240:241], v26 offset:22528
    ds_read_b64_tr_b16 a[242:243], v26 offset:23040
    ds_read_b64_tr_b16 a[244:245], v27 offset:22528
    ds_read_b64_tr_b16 a[246:247], v27 offset:23040
    v_mfma_f32_32x32x16_bf16 v[112:127], a[252:255], a[16:19], v[112:127]
    v_mfma_f32_32x32x16_bf16 v[96:111], a[224:227], a[128:131], v[96:111]
    ds_read_b64_tr_b16 a[248:249], v26 offset:24576
    ds_read_b64_tr_b16 a[250:251], v26 offset:25088
    ds_read_b64_tr_b16 a[252:253], v27 offset:24576
    ds_read_b64_tr_b16 a[254:255], v27 offset:25088
    s_add_u32 m0, s85, 122880
    s_mul_i32 s93, s9, 14
    v_add_u32 v62, s93, v7
    buffer_load_dwordx4 v62, s[64:67], 0 offen offset:0 lds
    v_mfma_f32_32x32x16_bf16 v[112:127], a[228:231], a[128:131], v[112:127]
    buffer_load_dwordx4 v62, s[64:67], s89 offen offset:1024 lds
    s_waitcnt lgkmcnt(4)
    v_mfma_f32_32x32x16_bf16 v[96:111], a[232:235], a[20:23], v[96:111]
    ds_read_b64_tr_b16 a[224:225], v26 offset:26624
    ds_read_b64_tr_b16 a[226:227], v26 offset:27136
    ds_read_b64_tr_b16 a[228:229], v27 offset:26624
    ds_read_b64_tr_b16 a[230:231], v27 offset:27136
    v_mfma_f32_32x32x16_bf16 v[112:127], a[236:239], a[20:23], v[112:127]
    v_mfma_f32_32x32x16_bf16 v[96:111], a[240:243], a[132:135], v[96:111]
    ds_read_b64_tr_b16 a[232:233], v26 offset:28672
    ds_read_b64_tr_b16 a[234:235], v26 offset:29184
    ds_read_b64_tr_b16 a[236:237], v27 offset:28672
    ds_read_b64_tr_b16 a[238:239], v27 offset:29184
    v_mfma_f32_32x32x16_bf16 v[112:127], a[244:247], a[132:135], v[112:127]
    s_waitcnt lgkmcnt(4)
    v_mfma_f32_32x32x16_bf16 v[96:111], a[248:251], a[24:27], v[96:111]
    ds_read_b64_tr_b16 a[240:241], v26 offset:30720
    ds_read_b64_tr_b16 a[242:243], v26 offset:31232
    ds_read_b64_tr_b16 a[244:245], v27 offset:30720
    ds_read_b64_tr_b16 a[246:247], v27 offset:31232
    buffer_load_dword v60, v33, s[72:75], 0 offen offset:256 sc1
    v_mfma_f32_32x32x16_bf16 v[112:127], a[252:255], a[24:27], v[112:127]
    v_mfma_f32_32x32x16_bf16 v[96:111], a[224:227], a[136:139], v[96:111]
    ds_read_b64_tr_b16 a[248:249], v26 offset:32768
    ds_read_b64_tr_b16 a[250:251], v26 offset:33280
    ds_read_b64_tr_b16 a[252:253], v27 offset:32768
    ds_read_b64_tr_b16 a[254:255], v27 offset:33280
    v_mfma_f32_32x32x16_bf16 v[112:127], a[228:231], a[136:139], v[112:127]
    s_waitcnt lgkmcnt(4)
    v_mfma_f32_32x32x16_bf16 v[96:111], a[232:235], a[28:31], v[96:111]
    ds_read_b64_tr_b16 a[224:225], v26 offset:34816
    ds_read_b64_tr_b16 a[226:227], v26 offset:35328
    ds_read_b64_tr_b16 a[228:229], v27 offset:34816
    ds_read_b64_tr_b16 a[230:231], v27 offset:35328
    v_mfma_f32_32x32x16_bf16 v[112:127], a[236:239], a[28:31], v[112:127]
    s_barrier
    s_add_u32 m0, s85, 131072
    s_mul_i32 s93, s17, 14
    v_add_u32 v62, s93, v7
    buffer_load_dwordx4 v62, s[64:67], 0 offen offset:0 lds
    v_mfma_f32_32x32x16_bf16 v[96:111], a[240:243], a[140:143], v[96:111]
    ds_read_b64_tr_b16 a[232:233], v26 offset:36864
    ds_read_b64_tr_b16 a[234:235], v26 offset:37376
    ds_read_b64_tr_b16 a[236:237], v27 offset:36864
    ds_read_b64_tr_b16 a[238:239], v27 offset:37376
    buffer_load_dwordx4 v62, s[64:67], s89 offen offset:1024 lds
    v_mfma_f32_32x32x16_bf16 v[112:127], a[244:247], a[140:143], v[112:127]
    s_add_u32 m0, s85, 139264
    s_mul_i32 s93, s20, 14
    v_add_u32 v62, s93, v7
    buffer_load_dwordx4 v62, s[64:67], 0 offen offset:0 lds
    s_waitcnt lgkmcnt(4)
    v_mfma_f32_32x32x16_bf16 v[96:111], a[248:251], a[32:35], v[96:111]
    ds_read_b64_tr_b16 a[240:241], v26 offset:38912
    ds_read_b64_tr_b16 a[242:243], v26 offset:39424
    ds_read_b64_tr_b16 a[244:245], v27 offset:38912
    ds_read_b64_tr_b16 a[246:247], v27 offset:39424
    buffer_load_dwordx4 v62, s[64:67], s89 offen offset:1024 lds
    v_mfma_f32_32x32x16_bf16 v[112:127], a[252:255], a[32:35], v[112:127]
    v_mfma_f32_32x32x16_bf16 v[96:111], a[224:227], a[144:147], v[96:111]
    ds_read_b64_tr_b16 a[248:249], v26 offset:40960
    ds_read_b64_tr_b16 a[250:251], v26 offset:41472
    ds_read_b64_tr_b16 a[252:253], v27 offset:40960
    ds_read_b64_tr_b16 a[254:255], v27 offset:41472
    s_add_u32 m0, s85, 16384
    s_mul_i32 s93, s21, 14
    v_add_u32 v62, s93, v7
    buffer_load_dwordx4 v62, s[64:67], 0 offen offset:0 lds
    v_mfma_f32_32x32x16_bf16 v[112:127], a[228:231], a[144:147], v[112:127]
    buffer_load_dwordx4 v62, s[64:67], s89 offen offset:1024 lds
    s_waitcnt lgkmcnt(4)
    v_mfma_f32_32x32x16_bf16 v[96:111], a[232:235], a[36:39], v[96:111]
    ds_read_b64_tr_b16 a[224:225], v26 offset:43008
    ds_read_b64_tr_b16 a[226:227], v26 offset:43520
    ds_read_b64_tr_b16 a[228:229], v27 offset:43008
    ds_read_b64_tr_b16 a[230:231], v27 offset:43520
    v_mfma_f32_32x32x16_bf16 v[112:127], a[236:239], a[36:39], v[112:127]
    s_add_u32 m0, s85, 24576
    s_mul_i32 s93, s90, 14
    v_add_u32 v62, s93, v7
    buffer_load_dwordx4 v62, s[64:67], 0 offen offset:0 lds
    v_mfma_f32_32x32x16_bf16 v[96:111], a[240:243], a[148:151], v[96:111]
    ds_read_b64_tr_b16 a[232:233], v26 offset:45056
    ds_read_b64_tr_b16 a[234:235], v26 offset:45568
    ds_read_b64_tr_b16 a[236:237], v27 offset:45056
    ds_read_b64_tr_b16 a[238:239], v27 offset:45568
    v_mfma_f32_32x32x16_bf16 v[112:127], a[244:247], a[148:151], v[112:127]
    buffer_load_dwordx4 v62, s[64:67], s89 offen offset:1024 lds
    s_waitcnt lgkmcnt(4)
    v_mfma_f32_32x32x16_bf16 v[96:111], a[248:251], a[40:43], v[96:111]
    ds_read_b64_tr_b16 a[240:241], v26 offset:47104
    ds_read_b64_tr_b16 a[242:243], v26 offset:47616
    ds_read_b64_tr_b16 a[244:245], v27 offset:47104
    ds_read_b64_tr_b16 a[246:247], v27 offset:47616
    s_waitcnt vmcnt(11)
    buffer_store_dword v59, v32, s[72:75], 0 offen offset:128 sc1
    buffer_load_dwordx2 v[160:161], v39, s[72:75], 0 offen sc1
    v_lshrrev_b32 v224, 3, v1
    v_and_b32 v225, 7, v1
    v_mfma_f32_32x32x16_bf16 v[112:127], a[252:255], a[40:43], v[112:127]
    v_and_b32 v226, 3, v224
    v_lshrrev_b32 v227, 2, v224
    v_lshl_add_u32 v226, v227, 4, v226
    v_mul_u32_u24 v226, 896, v226
    s_lshl_b32 s3, s82, 1
    s_add_u32 s3, s3, s83
    s_lshl_b32 s3, s3, 6
    v_lshl_add_u32 v227, v225, 3, s3
    s_mul_i32 s3, s97, 28672
    v_add3_u32 v173, v226, v227, s3
    v_lshlrev_b32 v172, 1, v173
    v_mfma_f32_32x32x16_bf16 v[96:111], a[224:227], a[152:155], v[96:111]
    ds_read_b64_tr_b16 a[248:249], v26 offset:49152
    ds_read_b64_tr_b16 a[250:251], v26 offset:49664
    ds_read_b64_tr_b16 a[252:253], v27 offset:49152
    ds_read_b64_tr_b16 a[254:255], v27 offset:49664
    buffer_load_dwordx2 v[180:181], v173, s[44:47], 0 offen
    buffer_load_dwordx2 v[182:183], v173, s[44:47], 0 offen offset:3584
    s_movk_i32 s3, 7168
    v_mfma_f32_32x32x16_bf16 v[112:127], a[228:231], a[152:155], v[112:127]
    buffer_load_dwordx2 v[184:185], v173, s[44:47], s3 offen
    buffer_load_dwordx2 v[186:187], v173, s[44:47], s3 offen offset:3584
    s_add_u32 s3, s84, 32768
    v_xor_b32 v225, v225, v224
    v_lshlrev_b32 v226, 7, v224
    v_lshl_add_u32 v225, v225, 4, v226
    v_add_u32 v163, s3, v225
    v_and_b32 v228, 31, v1
    v_lshrrev_b32 v229, 5, v1
    s_waitcnt lgkmcnt(4)
    v_mfma_f32_32x32x16_bf16 v[96:111], a[232:235], a[44:47], v[96:111]
    ds_read_b64_tr_b16 a[224:225], v26 offset:51200
    ds_read_b64_tr_b16 a[226:227], v26 offset:51712
    ds_read_b64_tr_b16 a[228:229], v27 offset:51200
    ds_read_b64_tr_b16 a[230:231], v27 offset:51712
    v_lshl_add_u32 v230, v228, 7, s3
    v_and_b32 v231, 7, v228
    v_xor_b32 v231, v229, v231
    v_lshl_add_u32 v164, v231, 4, v230
    v_xor_b32 v165, 32, v164
    v_xor_b32 v166, 64, v164
    v_xor_b32 v167, 96, v164
    v_mfma_f32_32x32x16_bf16 v[112:127], a[236:239], a[44:47], v[112:127]
    s_lshl_b32 s3, s43, 7
    v_lshl_add_u32 v170, v228, 2, s3
    v_lshl_add_u32 v171, v224, 2, s3
    s_mul_i32 s3, s80, 7
    s_add_u32 s3, s3, s82
    s_lshl_b32 s3, s3, 1
    s_add_u32 s3, s3, s83
    s_lshl_b32 s3, s3, 14
    s_add_u32 s3, s3, s84
    s_add_u32 s3, s3, 11927552
    v_lshl_add_u32 v169, v1, 4, s3
    v_xor_b32 v168, 0x4000, v169
    s_mov_b32 s41, 0xffff0000
    v_mfma_f32_32x32x16_bf16 v[96:111], a[240:243], a[156:159], v[96:111]
    ds_read_b64_tr_b16 a[232:233], v26 offset:53248
    ds_read_b64_tr_b16 a[234:235], v26 offset:53760
    ds_read_b64_tr_b16 a[236:237], v27 offset:53248
    ds_read_b64_tr_b16 a[238:239], v27 offset:53760
    s_waitcnt vmcnt(14)
    v_cmp_ne_u32 vcc, v60, v59
    s_cbranch_vccnz SLOW_F1
BACK_F1:
    s_lshl_b32 s94, s91, 5
    s_add_u32 s94, s94, s11
    buffer_load_dwordx4 a[56:59], v31, s[72:75], s94 offen offset:0 sc1
    v_mfma_f32_32x32x16_bf16 v[112:127], a[244:247], a[156:159], v[112:127]
    buffer_load_dwordx4 a[168:171], v31, s[72:75], s94 offen offset:1024 sc1
    s_waitcnt lgkmcnt(4)
    v_mfma_f32_32x32x16_bf16 v[96:111], a[248:251], a[48:51], v[96:111]
    ds_read_b64_tr_b16 a[240:241], v26 offset:55296
    ds_read_b64_tr_b16 a[242:243], v26 offset:55808
    ds_read_b64_tr_b16 a[244:245], v27 offset:55296
    ds_read_b64_tr_b16 a[246:247], v27 offset:55808
    buffer_load_dwordx4 a[60:63], v31, s[72:75], s94 offen offset:2048 sc1
    v_mfma_f32_32x32x16_bf16 v[112:127], a[252:255], a[48:51], v[112:127]
    s_barrier
    buffer_load_dwordx4 a[172:175], v31, s[72:75], s94 offen offset:3072 sc1
    v_mfma_f32_32x32x16_bf16 v[96:111], a[224:227], a[160:163], v[96:111]
    ds_read_b128 a[248:251], v22 offset:57344
    ds_read_b128 a[252:255], v22 offset:61440
    s_lshl_b32 s94, s39, 5
    s_add_u32 s94, s94, s11
    buffer_load_dwordx4 a[64:67], v31, s[72:75], s94 offen offset:0 sc1
    v_mfma_f32_32x32x16_bf16 v[112:127], a[228:231], a[160:163], v[112:127]
    buffer_load_dwordx4 a[176:179], v31, s[72:75], s94 offen offset:1024 sc1
    s_waitcnt lgkmcnt(2)
    v_mfma_f32_32x32x16_bf16 v[96:111], a[232:235], a[52:55], v[96:111]
    ds_read_b128 a[224:227], v23 offset:57344
    ds_read_b128 a[228:231], v23 offset:61440
    buffer_load_dwordx4 a[68:71], v31, s[72:75], s94 offen offset:2048 sc1
    v_mfma_f32_32x32x16_bf16 v[112:127], a[236:239], a[52:55], v[112:127]
    buffer_load_dwordx4 a[180:183], v31, s[72:75], s94 offen offset:3072 sc1
    v_mfma_f32_32x32x16_bf16 v[96:111], a[240:243], a[164:167], v[96:111]
    ds_read_b128 a[232:235], v24 offset:57344
    ds_read_b128 a[236:239], v24 offset:61440
    s_lshl_b32 s94, s40, 5
    s_add_u32 s94, s94, s11
    buffer_load_dwordx4 a[72:75], v31, s[72:75], s94 offen offset:0 sc1
    v_mfma_f32_32x32x16_bf16 v[112:127], a[244:247], a[164:167], v[112:127]
    buffer_load_dwordx4 a[184:187], v31, s[72:75], s94 offen offset:1024 sc1
    s_waitcnt vmcnt(8) lgkmcnt(2)
    v_mfma_f32_32x32x16_bf16 v[64:79], a[248:251], a[56:59], 0
    ds_read_b128 a[240:243], v25 offset:57344
    ds_read_b128 a[244:247], v25 offset:61440
    buffer_load_dwordx4 a[76:79], v31, s[72:75], s94 offen offset:2048 sc1
    v_mfma_f32_32x32x16_bf16 v[80:95], a[252:255], a[56:59], 0
    buffer_load_dwordx4 a[188:191], v31, s[72:75], s94 offen offset:3072 sc1
    v_mfma_f32_32x32x16_bf16 v[64:79], a[224:227], a[168:171], v[64:79]
    v_add_u32 v22, 0xc000, v22
    ds_read_b128 a[248:251], v22 offset:16384
    ds_read_b128 a[252:255], v22 offset:20480
    s_add_u32 s94, s16, s11
    buffer_load_dwordx4 a[80:83], v31, s[72:75], s94 offen offset:0 sc1
    v_mfma_f32_32x32x16_bf16 v[80:95], a[228:231], a[168:171], v[80:95]
    buffer_load_dwordx4 a[192:195], v31, s[72:75], s94 offen offset:1024 sc1
    s_waitcnt vmcnt(10) lgkmcnt(2)
    v_mfma_f32_32x32x16_bf16 v[64:79], a[232:235], a[60:63], v[64:79]
    v_add_u32 v23, 0xc000, v23
    ds_read_b128 a[224:227], v23 offset:16384
    ds_read_b128 a[228:231], v23 offset:20480
    s_lshl_b32 s94, s91, 5
    s_add_u32 s94, s94, s8
    buffer_load_dwordx4 a[84:87], v31, s[72:75], s94 offen offset:0 sc1
    v_mfma_f32_32x32x16_bf16 v[80:95], a[236:239], a[60:63], v[80:95]
    buffer_load_dword v60, v33, s[72:75], 0 offen offset:128 sc1
    buffer_load_dwordx4 a[196:199], v31, s[72:75], s94 offen offset:1024 sc1
    v_mfma_f32_32x32x16_bf16 v[64:79], a[240:243], a[172:175], v[64:79]
    v_add_u32 v24, 0xc000, v24
    ds_read_b128 a[232:235], v24 offset:16384
    ds_read_b128 a[236:239], v24 offset:20480
    buffer_load_dwordx4 a[88:91], v31, s[72:75], s94 offen offset:2048 sc1
    v_mfma_f32_32x32x16_bf16 v[80:95], a[244:247], a[172:175], v[80:95]
    buffer_load_dwordx4 a[200:203], v31, s[72:75], s94 offen offset:3072 sc1
    s_waitcnt vmcnt(13) lgkmcnt(2)
    v_mfma_f32_32x32x16_bf16 v[64:79], a[248:251], a[64:67], v[64:79]
    v_add_u32 v25, 0xc000, v25
    ds_read_b128 a[240:243], v25 offset:16384
    ds_read_b128 a[244:247], v25 offset:20480
    s_lshl_b32 s94, s39, 5
    s_add_u32 s94, s94, s8
    buffer_load_dwordx4 a[92:95], v31, s[72:75], s94 offen offset:0 sc1
    v_mfma_f32_32x32x16_bf16 v[80:95], a[252:255], a[64:67], v[80:95]
    buffer_load_dwordx4 a[204:207], v31, s[72:75], s94 offen offset:1024 sc1
    v_mfma_f32_32x32x16_bf16 v[64:79], a[224:227], a[176:179], v[64:79]
    ds_read_b128 a[248:251], v22 offset:24576
    ds_read_b128 a[252:255], v22 offset:28672
    buffer_load_dwordx4 a[96:99], v31, s[72:75], s94 offen offset:2048 sc1
    v_mfma_f32_32x32x16_bf16 v[80:95], a[228:231], a[176:179], v[80:95]
    buffer_load_dwordx4 a[208:211], v31, s[72:75], s94 offen offset:3072 sc1
    s_waitcnt vmcnt(15) lgkmcnt(2)
    v_mfma_f32_32x32x16_bf16 v[64:79], a[232:235], a[68:71], v[64:79]
    ds_read_b128 a[224:227], v23 offset:24576
    ds_read_b128 a[228:231], v23 offset:28672
    s_lshl_b32 s94, s40, 5
    s_add_u32 s94, s94, s8
    buffer_load_dwordx4 a[100:103], v31, s[72:75], s94 offen offset:0 sc1
    v_cmp_ne_u32 vcc, v161, v59
    s_cbranch_vccnz SLOW_G
BACK_G:
    v_mfma_f32_32x32x16_bf16 v[80:95], a[236:239], a[68:71], v[80:95]
    buffer_load_dwordx4 a[212:215], v31, s[72:75], s94 offen offset:1024 sc1
    ds_write_b32 v170, v160 offset:4096
    v_sub_f32 v162, 1.0, v160
    v_cvt_pk_bf16_f32 v162, v162, v162
    v_and_b32 v162, s41, v162
    ds_read_b32 v204, v171 offset:4096
    ds_read_b32 v205, v171 offset:4128
    v_mfma_f32_32x32x16_bf16 v[64:79], a[240:243], a[180:183], v[64:79]
    ds_read_b128 a[232:235], v24 offset:24576
    ds_read_b128 a[236:239], v24 offset:28672
    buffer_load_dwordx4 a[104:107], v31, s[72:75], s94 offen offset:2048 sc1
    ds_read_b32 v206, v171 offset:4160
    ds_read_b32 v207, v171 offset:4192
    v_lshlrev_b32 v176, 16, v250
    v_and_b32 v177, s41, v250
    v_lshlrev_b32 v178, 16, v251
    v_mfma_f32_32x32x16_bf16 v[80:95], a[244:247], a[180:183], v[80:95]
    buffer_load_dwordx4 a[216:219], v31, s[72:75], s94 offen offset:3072 sc1
    v_and_b32 v179, s41, v251
    v_lshlrev_b32 v188, 16, v180
    v_and_b32 v189, s41, v180
    v_mul_f32 v188, v188, v176
    v_mul_f32 v189, v189, v177
    v_lshlrev_b32 v190, 16, v181
    v_and_b32 v191, s41, v181
    v_mul_f32 v190, v190, v178
    s_waitcnt vmcnt(17) lgkmcnt(7)
    v_mfma_f32_32x32x16_bf16 v[64:79], a[248:251], a[72:75], v[64:79]
    ds_read_b128 a[240:243], v25 offset:24576
    ds_read_b128 a[244:247], v25 offset:28672
    v_mul_f32 v191, v191, v179
    v_lshlrev_b32 v192, 16, v182
    v_and_b32 v193, s41, v182
    v_mul_f32 v192, v192, v176
    v_mul_f32 v193, v193, v177
    v_lshlrev_b32 v194, 16, v183
    v_and_b32 v195, s41, v183
    v_mul_f32 v194, v194, v178
    v_mul_f32 v195, v195, v179
    v_lshlrev_b32 v196, 16, v184
    v_and_b32 v197, s41, v184
    v_mfma_f32_32x32x16_bf16 v[80:95], a[252:255], a[72:75], v[80:95]
    v_mul_f32 v196, v196, v176
    v_mul_f32 v197, v197, v177
    v_lshlrev_b32 v198, 16, v185
    v_and_b32 v199, s41, v185
    v_mul_f32 v198, v198, v178
    v_mul_f32 v199, v199, v179
    v_lshlrev_b32 v200, 16, v186
    v_and_b32 v201, s41, v186
    v_mul_f32 v200, v200, v176
    v_mul_f32 v201, v201, v177
    v_lshlrev_b32 v202, 16, v187
    v_and_b32 v203, s41, v187
    v_mul_f32 v202, v202, v178
    v_mul_f32 v203, v203, v179
    v_mfma_f32_32x32x16_bf16 v[64:79], a[224:227], a[184:187], v[64:79]
    v_add_u32 v14, 0xc000, v14
    ds_read_b128 a[248:251], v14 offset:32768
    ds_read_b128 a[252:255], v14 offset:36864
    s_add_u32 s94, s16, s8
    buffer_load_dwordx4 a[108:111], v31, s[72:75], s94 offen offset:0 sc1
    s_cmp_eq_u32 s80, 15
    s_cselect_b32 s3, 0, 0x40000000
    v_add_u32 v224, s3, v32
    v_mfma_f32_32x32x16_bf16 v[80:95], a[228:231], a[184:187], v[80:95]
    buffer_load_dwordx4 a[220:223], v31, s[72:75], s94 offen offset:1024 sc1
    buffer_store_dword v59, v224, s[72:75], 0 offen offset:384 sc1
    s_movk_i32 s41, 0xff
    s_waitcnt vmcnt(18) lgkmcnt(2)
    v_mfma_f32_32x32x16_bf16 v[64:79], a[232:235], a[76:79], v[64:79]
    v_add_u32 v15, 0xc000, v15
    ds_read_b128 a[224:227], v15 offset:32768
    ds_read_b128 a[228:231], v15 offset:36864
    v_mfma_f32_32x32x16_bf16 v[80:95], a[236:239], a[76:79], v[80:95]
    v_mfma_f32_32x32x16_bf16 v[64:79], a[240:243], a[188:191], v[64:79]
    ds_read_b128 a[232:235], v22 offset:40960
    ds_read_b128 a[236:239], v22 offset:45056
    v_mfma_f32_32x32x16_bf16 v[80:95], a[244:247], a[188:191], v[80:95]
    s_waitcnt vmcnt(16) lgkmcnt(2)
    v_mfma_f32_32x32x16_bf16 v[64:79], a[248:251], a[80:83], v[64:79]
    ds_read_b128 a[240:243], v23 offset:40960
    ds_read_b128 a[244:247], v23 offset:45056
    v_mfma_f32_32x32x16_bf16 v[80:95], a[252:255], a[80:83], v[80:95]
    v_mfma_f32_32x32x16_bf16 v[64:79], a[224:227], a[192:195], v[64:79]
    ds_read_b128 a[248:251], v24 offset:40960
    ds_read_b128 a[252:255], v24 offset:45056
    s_waitcnt vmcnt(14)
    v_cmp_ne_u32 vcc, v60, v59
    s_cbranch_vccnz SLOW_F2
BACK_F2:
    s_add_u32 s94, s4, 4096
    buffer_load_dwordx4 a[0:3], v30, s[72:75], s94 offen offset:0 sc1
    v_mfma_f32_32x32x16_bf16 v[80:95], a[228:231], a[192:195], v[80:95]
    buffer_load_dwordx4 a[112:115], v30, s[72:75], s94 offen offset:1024 sc1
    s_waitcnt vmcnt(15) lgkmcnt(2)
    v_mfma_f32_32x32x16_bf16 v[64:79], a[232:235], a[84:87], v[64:79]
    ds_read_b128 a[224:227], v25 offset:40960
    ds_read_b128 a[228:231], v25 offset:45056
    buffer_load_dwordx4 a[4:7], v30, s[72:75], s94 offen offset:2048 sc1
    v_mfma_f32_32x32x16_bf16 v[80:95], a[236:239], a[84:87], v[80:95]
    buffer_load_dwordx4 a[116:119], v30, s[72:75], s94 offen offset:3072 sc1
    v_mfma_f32_32x32x16_bf16 v[64:79], a[240:243], a[196:199], v[64:79]
    ds_read_b128 a[232:235], v22 offset:49152
    ds_read_b128 a[236:239], v22 offset:53248
    s_add_u32 s94, s5, 4096
    buffer_load_dwordx4 a[8:11], v30, s[72:75], s94 offen offset:0 sc1
    v_mfma_f32_32x32x16_bf16 v[80:95], a[244:247], a[196:199], v[80:95]
    buffer_load_dwordx4 a[120:123], v30, s[72:75], s94 offen offset:1024 sc1
    s_waitcnt vmcnt(17) lgkmcnt(2)
    v_mfma_f32_32x32x16_bf16 v[64:79], a[248:251], a[88:91], v[64:79]
    ds_read_b128 a[240:243], v23 offset:49152
    ds_read_b128 a[244:247], v23 offset:53248
    buffer_load_dwordx4 a[12:15], v30, s[72:75], s94 offen offset:2048 sc1
    v_mfma_f32_32x32x16_bf16 v[80:95], a[252:255], a[88:91], v[80:95]
    buffer_load_dwordx4 a[124:127], v30, s[72:75], s94 offen offset:3072 sc1
    v_mfma_f32_32x32x16_bf16 v[64:79], a[224:227], a[200:203], v[64:79]
    ds_read_b128 a[248:251], v24 offset:49152
    ds_read_b128 a[252:255], v24 offset:53248
    s_add_u32 s94, s9, 4096
    buffer_load_dwordx4 a[16:19], v30, s[72:75], s94 offen offset:0 sc1
    v_mfma_f32_32x32x16_bf16 v[80:95], a[228:231], a[200:203], v[80:95]
    buffer_load_dwordx4 a[128:131], v30, s[72:75], s94 offen offset:1024 sc1
    s_waitcnt vmcnt(19) lgkmcnt(2)
    v_mfma_f32_32x32x16_bf16 v[64:79], a[232:235], a[92:95], v[64:79]
    ds_read_b128 a[224:227], v25 offset:49152
    ds_read_b128 a[228:231], v25 offset:53248
    buffer_load_dwordx4 a[20:23], v30, s[72:75], s94 offen offset:2048 sc1
    v_mfma_f32_32x32x16_bf16 v[80:95], a[236:239], a[92:95], v[80:95]
    buffer_load_dwordx4 a[132:135], v30, s[72:75], s94 offen offset:3072 sc1
    v_mfma_f32_32x32x16_bf16 v[64:79], a[240:243], a[204:207], v[64:79]
    ds_read_b128 a[232:235], v22 offset:57344
    ds_read_b128 a[236:239], v22 offset:61440
    s_add_u32 s94, s17, 4096
    buffer_load_dwordx4 a[24:27], v30, s[72:75], s94 offen offset:0 sc1
    v_mfma_f32_32x32x16_bf16 v[80:95], a[244:247], a[204:207], v[80:95]
    buffer_load_dwordx4 a[136:139], v30, s[72:75], s94 offen offset:1024 sc1
    s_waitcnt vmcnt(21) lgkmcnt(2)
    v_mfma_f32_32x32x16_bf16 v[64:79], a[248:251], a[96:99], v[64:79]
    ds_read_b128 a[240:243], v23 offset:57344
    ds_read_b128 a[244:247], v23 offset:61440
    buffer_load_dwordx4 a[28:31], v30, s[72:75], s94 offen offset:2048 sc1
    v_mfma_f32_32x32x16_bf16 v[80:95], a[252:255], a[96:99], v[80:95]
    buffer_load_dwordx4 a[140:143], v30, s[72:75], s94 offen offset:3072 sc1
    v_mfma_f32_32x32x16_bf16 v[64:79], a[224:227], a[208:211], v[64:79]
    ds_read_b128 a[248:251], v24 offset:57344
    ds_read_b128 a[252:255], v24 offset:61440
    s_add_u32 s94, s20, 4096
    buffer_load_dwordx4 a[32:35], v30, s[72:75], s94 offen offset:0 sc1
    v_mfma_f32_32x32x16_bf16 v[80:95], a[228:231], a[208:211], v[80:95]
    buffer_load_dwordx4 a[144:147], v30, s[72:75], s94 offen offset:1024 sc1
    s_waitcnt vmcnt(23) lgkmcnt(2)
    v_mfma_f32_32x32x16_bf16 v[64:79], a[232:235], a[100:103], v[64:79]
    ds_read_b128 a[224:227], v25 offset:57344
    ds_read_b128 a[228:231], v25 offset:61440
    buffer_load_dwordx4 a[36:39], v30, s[72:75], s94 offen offset:2048 sc1
    v_mfma_f32_32x32x16_bf16 v[80:95], a[236:239], a[100:103], v[80:95]
    buffer_load_dwordx4 a[148:151], v30, s[72:75], s94 offen offset:3072 sc1
    v_mfma_f32_32x32x16_bf16 v[64:79], a[240:243], a[212:215], v[64:79]
    v_add_u32 v14, 0xc000, v14
    ds_read_b128 a[232:235], v14 offset:49152
    ds_read_b128 a[236:239], v14 offset:53248
    s_add_u32 s94, s21, 4096
    buffer_load_dwordx4 a[40:43], v30, s[72:75], s94 offen offset:0 sc1
    v_mfma_f32_32x32x16_bf16 v[80:95], a[244:247], a[212:215], v[80:95]
    buffer_load_dwordx4 a[152:155], v30, s[72:75], s94 offen offset:1024 sc1
    s_waitcnt vmcnt(25) lgkmcnt(2)
    v_mfma_f32_32x32x16_bf16 v[64:79], a[248:251], a[104:107], v[64:79]
    v_add_u32 v15, 0xc000, v15
    ds_read_b128 a[240:243], v15 offset:49152
    ds_read_b128 a[244:247], v15 offset:53248
    buffer_load_dwordx4 a[44:47], v30, s[72:75], s94 offen offset:2048 sc1
    v_mfma_f32_32x32x16_bf16 v[80:95], a[252:255], a[104:107], v[80:95]
    s_barrier
    buffer_load_dwordx4 a[156:159], v30, s[72:75], s94 offen offset:3072 sc1
    v_mfma_f32_32x32x16_bf16 v[64:79], a[224:227], a[216:219], v[64:79]
    v_add_u32 v26, 0x18000, v26
    ds_read_b64_tr_b16 a[248:249], v26 offset:57344
    ds_read_b64_tr_b16 a[250:251], v26 offset:57856
    ds_read_b64_tr_b16 a[252:253], v26 offset:59392
    ds_read_b64_tr_b16 a[254:255], v26 offset:59904
    s_add_u32 s94, s90, 4096
    buffer_load_dwordx4 a[48:51], v30, s[72:75], s94 offen offset:0 sc1
    v_mfma_f32_32x32x16_bf16 v[80:95], a[228:231], a[216:219], v[80:95]
    buffer_load_dwordx4 a[160:163], v30, s[72:75], s94 offen offset:1024 sc1
    s_waitcnt vmcnt(27) lgkmcnt(4)
    v_mfma_f32_32x32x16_bf16 v[64:79], a[232:235], a[108:111], v[64:79]
    ds_read_b64_tr_b16 a[224:225], v26 offset:61440
    ds_read_b64_tr_b16 a[226:227], v26 offset:61952
    ds_read_b64_tr_b16 a[228:229], v26 offset:63488
    ds_read_b64_tr_b16 a[230:231], v26 offset:64000
    buffer_load_dwordx4 a[52:55], v30, s[72:75], s94 offen offset:2048 sc1
    v_mfma_f32_32x32x16_bf16 v[80:95], a[236:239], a[108:111], v[80:95]
    buffer_load_dwordx4 a[164:167], v30, s[72:75], s94 offen offset:3072 sc1
    v_mfma_f32_32x32x16_bf16 v[64:79], a[240:243], a[220:223], v[64:79]
    ds_read_b64_tr_b16 a[232:233], v26 offset:16384
    ds_read_b64_tr_b16 a[234:235], v26 offset:16896
    ds_read_b64_tr_b16 a[236:237], v26 offset:18432
    ds_read_b64_tr_b16 a[238:239], v26 offset:18944
    v_mfma_f32_32x32x16_bf16 v[80:95], a[244:247], a[220:223], v[80:95]
    s_waitcnt vmcnt(24) lgkmcnt(4)
    v_mfma_f32_32x32x16_bf16 v[96:111], a[248:251], a[0:3], v[96:111]
    ds_read_b64_tr_b16 a[240:241], v26 offset:20480
    ds_read_b64_tr_b16 a[242:243], v26 offset:20992
    ds_read_b64_tr_b16 a[244:245], v26 offset:22528
    ds_read_b64_tr_b16 a[246:247], v26 offset:23040
    v_mfma_f32_32x32x16_bf16 v[96:111], a[252:255], a[112:115], v[96:111]
    v_mfma_f32_32x32x16_bf16 v[96:111], a[224:227], a[4:7], v[96:111]
    ds_read_b64_tr_b16 a[248:249], v26 offset:24576
    ds_read_b64_tr_b16 a[250:251], v26 offset:25088
    ds_read_b64_tr_b16 a[252:253], v26 offset:26624
    ds_read_b64_tr_b16 a[254:255], v26 offset:27136
    v_mul_f32 v64, v160, v64
    v_mul_f32 v65, v160, v65
    v_mul_f32 v66, v160, v66
    v_mul_f32 v67, v160, v67
    v_mul_f32 v68, v160, v68
    v_mul_f32 v69, v160, v69
    v_mul_f32 v70, v160, v70
    v_mul_f32 v71, v160, v71
    v_mfma_f32_32x32x16_bf16 v[96:111], a[228:231], a[116:119], v[96:111]
    v_mul_f32 v72, v160, v72
    v_mul_f32 v73, v160, v73
    v_mul_f32 v74, v160, v74
    v_mul_f32 v75, v160, v75
    v_mul_f32 v76, v160, v76
    v_mul_f32 v77, v160, v77
    v_mul_f32 v78, v160, v78
    v_mul_f32 v79, v160, v79
    s_waitcnt vmcnt(20) lgkmcnt(4)
    v_mfma_f32_32x32x16_bf16 v[96:111], a[232:235], a[8:11], v[96:111]
    ds_read_b64_tr_b16 a[224:225], v26 offset:28672
    ds_read_b64_tr_b16 a[226:227], v26 offset:29184
    ds_read_b64_tr_b16 a[228:229], v26 offset:30720
    ds_read_b64_tr_b16 a[230:231], v26 offset:31232
    v_mfma_f32_32x32x16_bf16 v[96:111], a[236:239], a[120:123], v[96:111]
    v_mfma_f32_32x32x16_bf16 v[96:111], a[240:243], a[12:15], v[96:111]
    ds_read_b64_tr_b16 a[232:233], v26 offset:32768
    ds_read_b64_tr_b16 a[234:235], v26 offset:33280
    ds_read_b64_tr_b16 a[236:237], v26 offset:34816
    ds_read_b64_tr_b16 a[238:239], v26 offset:35328
    v_mfma_f32_32x32x16_bf16 v[96:111], a[244:247], a[124:127], v[96:111]
    s_waitcnt vmcnt(16) lgkmcnt(4)
    v_mfma_f32_32x32x16_bf16 v[96:111], a[248:251], a[16:19], v[96:111]
    ds_read_b64_tr_b16 a[240:241], v26 offset:36864
    ds_read_b64_tr_b16 a[242:243], v26 offset:37376
    ds_read_b64_tr_b16 a[244:245], v26 offset:38912
    ds_read_b64_tr_b16 a[246:247], v26 offset:39424
    v_mfma_f32_32x32x16_bf16 v[96:111], a[252:255], a[128:131], v[96:111]
    v_mfma_f32_32x32x16_bf16 v[96:111], a[224:227], a[20:23], v[96:111]
    ds_read_b64_tr_b16 a[248:249], v26 offset:40960
    ds_read_b64_tr_b16 a[250:251], v26 offset:41472
    ds_read_b64_tr_b16 a[252:253], v26 offset:43008
    ds_read_b64_tr_b16 a[254:255], v26 offset:43520
    v_mfma_f32_32x32x16_bf16 v[96:111], a[228:231], a[132:135], v[96:111]
    s_waitcnt vmcnt(12) lgkmcnt(4)
    v_mfma_f32_32x32x16_bf16 v[96:111], a[232:235], a[24:27], v[96:111]
    ds_read_b64_tr_b16 a[224:225], v26 offset:45056
    ds_read_b64_tr_b16 a[226:227], v26 offset:45568
    ds_read_b64_tr_b16 a[228:229], v26 offset:47104
    ds_read_b64_tr_b16 a[230:231], v26 offset:47616
    v_mfma_f32_32x32x16_bf16 v[96:111], a[236:239], a[136:139], v[96:111]
    v_mfma_f32_32x32x16_bf16 v[96:111], a[240:243], a[28:31], v[96:111]
    v_subrev_u32 v26, 0x18000, v26
    ds_read_b64_tr_b16 a[232:233], v26 offset:16384
    ds_read_b64_tr_b16 a[234:235], v26 offset:16896
    ds_read_b64_tr_b16 a[236:237], v26 offset:18432
    ds_read_b64_tr_b16 a[238:239], v26 offset:18944
    v_mfma_f32_32x32x16_bf16 v[96:111], a[244:247], a[140:143], v[96:111]
    s_waitcnt vmcnt(8) lgkmcnt(4)
    v_mfma_f32_32x32x16_bf16 v[96:111], a[248:251], a[32:35], v[96:111]
    ds_read_b64_tr_b16 a[240:241], v26 offset:20480
    ds_read_b64_tr_b16 a[242:243], v26 offset:20992
    ds_read_b64_tr_b16 a[244:245], v26 offset:22528
    ds_read_b64_tr_b16 a[246:247], v26 offset:23040
    v_mfma_f32_32x32x16_bf16 v[96:111], a[252:255], a[144:147], v[96:111]
    v_mfma_f32_32x32x16_bf16 v[96:111], a[224:227], a[36:39], v[96:111]
    ds_read_b64_tr_b16 a[248:249], v26 offset:24576
    ds_read_b64_tr_b16 a[250:251], v26 offset:25088
    ds_read_b64_tr_b16 a[252:253], v26 offset:26624
    ds_read_b64_tr_b16 a[254:255], v26 offset:27136
    v_mfma_f32_32x32x16_bf16 v[96:111], a[228:231], a[148:151], v[96:111]
    s_waitcnt vmcnt(4) lgkmcnt(4)
    v_mfma_f32_32x32x16_bf16 v[96:111], a[232:235], a[40:43], v[96:111]
    ds_read_b64_tr_b16 a[224:225], v26 offset:28672
    ds_read_b64_tr_b16 a[226:227], v26 offset:29184
    ds_read_b64_tr_b16 a[228:229], v26 offset:30720
    ds_read_b64_tr_b16 a[230:231], v26 offset:31232
    v_mfma_f32_32x32x16_bf16 v[96:111], a[236:239], a[152:155], v[96:111]
    v_mfma_f32_32x32x16_bf16 v[96:111], a[240:243], a[44:47], v[96:111]
    v_add_u32 v27, 0x18000, v27
    ds_read_b64_tr_b16 a[232:233], v27 offset:57344
    ds_read_b64_tr_b16 a[234:235], v27 offset:57856
    ds_read_b64_tr_b16 a[236:237], v27 offset:59392
    ds_read_b64_tr_b16 a[238:239], v27 offset:59904
    v_mfma_f32_32x32x16_bf16 v[96:111], a[244:247], a[156:159], v[96:111]
    s_waitcnt vmcnt(0) lgkmcnt(4)
    v_mfma_f32_32x32x16_bf16 v[96:111], a[248:251], a[48:51], v[96:111]
    ds_read_b64_tr_b16 a[240:241], v27 offset:61440
    ds_read_b64_tr_b16 a[242:243], v27 offset:61952
    ds_read_b64_tr_b16 a[244:245], v27 offset:63488
    ds_read_b64_tr_b16 a[246:247], v27 offset:64000
    v_mfma_f32_32x32x16_bf16 v[96:111], a[252:255], a[160:163], v[96:111]
    v_mfma_f32_32x32x16_bf16 v[96:111], a[224:227], a[52:55], v[96:111]
    ds_read_b64_tr_b16 a[248:249], v27 offset:16384
    ds_read_b64_tr_b16 a[250:251], v27 offset:16896
    ds_read_b64_tr_b16 a[252:253], v27 offset:18432
    ds_read_b64_tr_b16 a[254:255], v27 offset:18944
    v_mfma_f32_32x32x16_bf16 v[96:111], a[228:231], a[164:167], v[96:111]
    s_waitcnt lgkmcnt(4)
    v_mfma_f32_32x32x16_bf16 v[112:127], a[232:235], a[0:3], v[112:127]
    ds_read_b64_tr_b16 a[224:225], v27 offset:20480
    ds_read_b64_tr_b16 a[226:227], v27 offset:20992
    ds_read_b64_tr_b16 a[228:229], v27 offset:22528
    ds_read_b64_tr_b16 a[230:231], v27 offset:23040
    v_mfma_f32_32x32x16_bf16 v[112:127], a[236:239], a[112:115], v[112:127]
    s_nop 4
    v_fmac_f32 v64, v162, v96
    v_fmac_f32 v65, v162, v97
    v_fmac_f32 v66, v162, v98
    v_fmac_f32 v67, v162, v99
    v_bfi_b32 v64, s41, v59, v64
    buffer_store_dwordx4 v[64:67], v168, s[72:75], 0 offen offset:0 sc1
    v_fmac_f32 v68, v162, v100
    v_fmac_f32 v69, v162, v101
    v_fmac_f32 v70, v162, v102
    v_fmac_f32 v71, v162, v103
    v_bfi_b32 v68, s41, v59, v68
    buffer_store_dwordx4 v[68:71], v168, s[72:75], 0 offen offset:1024 sc1
    v_fmac_f32 v72, v162, v104
    v_fmac_f32 v73, v162, v105
    v_fmac_f32 v74, v162, v106
    v_fmac_f32 v75, v162, v107
    v_bfi_b32 v72, s41, v59, v72
    v_mfma_f32_32x32x16_bf16 v[112:127], a[240:243], a[4:7], v[112:127]
    ds_read_b64_tr_b16 a[232:233], v27 offset:24576
    ds_read_b64_tr_b16 a[234:235], v27 offset:25088
    ds_read_b64_tr_b16 a[236:237], v27 offset:26624
    ds_read_b64_tr_b16 a[238:239], v27 offset:27136
    buffer_store_dwordx4 v[72:75], v168, s[72:75], 0 offen offset:2048 sc1
    v_fmac_f32 v76, v162, v108
    v_fmac_f32 v77, v162, v109
    v_fmac_f32 v78, v162, v110
    v_fmac_f32 v79, v162, v111
    v_bfi_b32 v76, s41, v59, v76
    buffer_store_dwordx4 v[76:79], v168, s[72:75], 0 offen offset:3072 sc1
    v_mfma_f32_32x32x16_bf16 v[112:127], a[244:247], a[116:119], v[112:127]
    v_mul_f32 v80, v160, v80
    v_mul_f32 v81, v160, v81
    v_mul_f32 v82, v160, v82
    v_mul_f32 v83, v160, v83
    v_mul_f32 v84, v160, v84
    v_mul_f32 v85, v160, v85
    v_mul_f32 v86, v160, v86
    v_mul_f32 v87, v160, v87
    v_mul_f32 v88, v160, v88
    v_mul_f32 v89, v160, v89
    v_mul_f32 v90, v160, v90
    v_mul_f32 v91, v160, v91
    v_mul_f32 v92, v160, v92
    s_waitcnt lgkmcnt(4)
    v_mfma_f32_32x32x16_bf16 v[112:127], a[248:251], a[8:11], v[112:127]
    ds_read_b64_tr_b16 a[240:241], v27 offset:28672
    ds_read_b64_tr_b16 a[242:243], v27 offset:29184
    ds_read_b64_tr_b16 a[244:245], v27 offset:30720
    ds_read_b64_tr_b16 a[246:247], v27 offset:31232
    v_mul_f32 v93, v160, v93
    v_mul_f32 v94, v160, v94
    v_mul_f32 v95, v160, v95
    v_mfma_f32_32x32x16_bf16 v[112:127], a[252:255], a[120:123], v[112:127]
    v_mfma_f32_32x32x16_bf16 v[112:127], a[224:227], a[12:15], v[112:127]
    ds_read_b64_tr_b16 a[248:249], v27 offset:32768
    ds_read_b64_tr_b16 a[250:251], v27 offset:33280
    ds_read_b64_tr_b16 a[252:253], v27 offset:34816
    ds_read_b64_tr_b16 a[254:255], v27 offset:35328
    v_mfma_f32_32x32x16_bf16 v[112:127], a[228:231], a[124:127], v[112:127]
    s_waitcnt lgkmcnt(4)
    v_mfma_f32_32x32x16_bf16 v[112:127], a[232:235], a[16:19], v[112:127]
    ds_read_b64_tr_b16 a[224:225], v27 offset:36864
    ds_read_b64_tr_b16 a[226:227], v27 offset:37376
    ds_read_b64_tr_b16 a[228:229], v27 offset:38912
    ds_read_b64_tr_b16 a[230:231], v27 offset:39424
    v_mfma_f32_32x32x16_bf16 v[112:127], a[236:239], a[128:131], v[112:127]
    v_mfma_f32_32x32x16_bf16 v[112:127], a[240:243], a[20:23], v[112:127]
    ds_read_b64_tr_b16 a[232:233], v27 offset:40960
    ds_read_b64_tr_b16 a[234:235], v27 offset:41472
    ds_read_b64_tr_b16 a[236:237], v27 offset:43008
    ds_read_b64_tr_b16 a[238:239], v27 offset:43520
    v_mfma_f32_32x32x16_bf16 v[112:127], a[244:247], a[132:135], v[112:127]
    s_waitcnt lgkmcnt(4)
    v_mfma_f32_32x32x16_bf16 v[112:127], a[248:251], a[24:27], v[112:127]
    ds_read_b64_tr_b16 a[240:241], v27 offset:45056
    ds_read_b64_tr_b16 a[242:243], v27 offset:45568
    ds_read_b64_tr_b16 a[244:245], v27 offset:47104
    ds_read_b64_tr_b16 a[246:247], v27 offset:47616
    v_mfma_f32_32x32x16_bf16 v[112:127], a[252:255], a[136:139], v[112:127]
    v_mfma_f32_32x32x16_bf16 v[112:127], a[224:227], a[28:31], v[112:127]
    v_subrev_u32 v27, 0x18000, v27
    ds_read_b64_tr_b16 a[248:249], v27 offset:16384
    ds_read_b64_tr_b16 a[250:251], v27 offset:16896
    ds_read_b64_tr_b16 a[252:253], v27 offset:18432
    ds_read_b64_tr_b16 a[254:255], v27 offset:18944
    v_mfma_f32_32x32x16_bf16 v[112:127], a[228:231], a[140:143], v[112:127]
    s_waitcnt lgkmcnt(4)
    v_mfma_f32_32x32x16_bf16 v[112:127], a[232:235], a[32:35], v[112:127]
    ds_read_b64_tr_b16 a[224:225], v27 offset:20480
    ds_read_b64_tr_b16 a[226:227], v27 offset:20992
    ds_read_b64_tr_b16 a[228:229], v27 offset:22528
    ds_read_b64_tr_b16 a[230:231], v27 offset:23040
    v_mfma_f32_32x32x16_bf16 v[112:127], a[236:239], a[144:147], v[112:127]
    v_mfma_f32_32x32x16_bf16 v[112:127], a[240:243], a[36:39], v[112:127]
    ds_read_b64_tr_b16 a[232:233], v27 offset:24576
    ds_read_b64_tr_b16 a[234:235], v27 offset:25088
    ds_read_b64_tr_b16 a[236:237], v27 offset:26624
    ds_read_b64_tr_b16 a[238:239], v27 offset:27136
    v_mfma_f32_32x32x16_bf16 v[112:127], a[244:247], a[148:151], v[112:127]
    s_waitcnt lgkmcnt(4)
    v_mfma_f32_32x32x16_bf16 v[112:127], a[248:251], a[40:43], v[112:127]
    ds_read_b64_tr_b16 a[240:241], v27 offset:28672
    ds_read_b64_tr_b16 a[242:243], v27 offset:29184
    ds_read_b64_tr_b16 a[244:245], v27 offset:30720
    ds_read_b64_tr_b16 a[246:247], v27 offset:31232
    v_mfma_f32_32x32x16_bf16 v[112:127], a[252:255], a[152:155], v[112:127]
    v_mfma_f32_32x32x16_bf16 v[112:127], a[224:227], a[44:47], v[112:127]
    v_mfma_f32_32x32x16_bf16 v[112:127], a[228:231], a[156:159], v[112:127]
    s_waitcnt lgkmcnt(0)
    v_mfma_f32_32x32x16_bf16 v[112:127], a[232:235], a[48:51], v[112:127]
    v_mfma_f32_32x32x16_bf16 v[112:127], a[236:239], a[160:163], v[112:127]
    v_mfma_f32_32x32x16_bf16 v[112:127], a[240:243], a[52:55], v[112:127]
    buffer_load_dwordx4 v[208:211], v169, s[72:75], 0 offen offset:0 sc1
    buffer_load_dwordx4 v[212:215], v169, s[72:75], 0 offen offset:1024 sc1
    buffer_load_dwordx4 v[216:219], v169, s[72:75], 0 offen offset:2048 sc1
    buffer_load_dwordx4 v[220:223], v169, s[72:75], 0 offen offset:3072 sc1
    v_mfma_f32_32x32x16_bf16 v[112:127], a[244:247], a[164:167], v[112:127]
    s_waitcnt vmcnt(3)
    v_xor_b32 v224, v208, v59
    s_waitcnt vmcnt(2)
    v_xor_b32 v225, v212, v59
    s_waitcnt vmcnt(1)
    v_xor_b32 v226, v216, v59
    s_waitcnt vmcnt(0)
    v_xor_b32 v227, v220, v59
    v_or3_b32 v224, v224, v225, v226
    v_or_b32 v224, v224, v227
    v_and_b32 v224, s41, v224
    v_cmp_ne_u32 vcc, 0, v224
    s_cbranch_vccnz SLOW_P
BACK_P:
    v_add_f32 v80, v80, v208
    v_add_f32 v81, v81, v209
    v_add_f32 v82, v82, v210
    v_add_f32 v83, v83, v211
    v_add_f32 v84, v84, v212
    v_add_f32 v85, v85, v213
    v_add_f32 v86, v86, v214
    v_add_f32 v87, v87, v215
    v_add_f32 v88, v88, v216
    v_add_f32 v89, v89, v217
    v_add_f32 v90, v90, v218
    v_add_f32 v91, v91, v219
    v_add_f32 v92, v92, v220
    v_add_f32 v93, v93, v221
    v_add_f32 v94, v94, v222
    v_add_f32 v95, v95, v223
    v_fmac_f32 v80, v162, v112
    v_fmac_f32 v81, v162, v113
    v_fmac_f32 v82, v162, v114
    v_fmac_f32 v83, v162, v115
    ds_write_b128 v164, v[80:83]
    v_fmac_f32 v84, v162, v116
    v_fmac_f32 v85, v162, v117
    v_fmac_f32 v86, v162, v118
    v_fmac_f32 v87, v162, v119
    ds_write_b128 v165, v[84:87]
    v_fmac_f32 v88, v162, v120
    v_fmac_f32 v89, v162, v121
    v_fmac_f32 v90, v162, v122
    v_fmac_f32 v91, v162, v123
    ds_write_b128 v166, v[88:91]
    v_fmac_f32 v92, v162, v124
    v_fmac_f32 v93, v162, v125
    v_fmac_f32 v94, v162, v126
    v_fmac_f32 v95, v162, v127
    ds_write_b128 v167, v[92:95]
    ds_read_b128 v[96:99], v163 offset:0
    ds_read_b128 v[100:103], v163 offset:1024
    ds_read_b128 v[104:107], v163 offset:2048
    ds_read_b128 v[108:111], v163 offset:3072
    s_waitcnt lgkmcnt(3)
    v_fmac_f32 v96, v204, v188
    v_fmac_f32 v97, v204, v189
    v_fmac_f32 v98, v204, v190
    v_fmac_f32 v99, v204, v191
    buffer_store_dwordx4 v[96:99], v172, s[76:79], 0 offen sc1
    s_waitcnt lgkmcnt(2)
    v_fmac_f32 v100, v205, v192
    v_fmac_f32 v101, v205, v193
    v_fmac_f32 v102, v205, v194
    v_fmac_f32 v103, v205, v195
    s_movk_i32 s3, 7168
    buffer_store_dwordx4 v[100:103], v172, s[76:79], s3 offen sc1
    s_waitcnt lgkmcnt(1)
    v_fmac_f32 v104, v206, v196
    v_fmac_f32 v105, v206, v197
    v_fmac_f32 v106, v206, v198
    v_fmac_f32 v107, v206, v199
    s_movk_i32 s3, 14336
    buffer_store_dwordx4 v[104:107], v172, s[76:79], s3 offen sc1
    s_waitcnt lgkmcnt(0)
    v_fmac_f32 v108, v207, v200
    v_fmac_f32 v109, v207, v201
    v_fmac_f32 v110, v207, v202
    v_fmac_f32 v111, v207, v203
    s_movk_i32 s3, 21504
    buffer_store_dwordx4 v[108:111], v172, s[76:79], s3 offen sc1
L_END:
    s_endpgm
SLOW_S:
    s_cmp_eq_u32 s96, 0
    s_cbranch_scc1 BACK_S
    s_sub_u32 s96, s96, 1
    s_sleep 1
    buffer_load_dwordx4 v[232:235], v35, s[72:75], 0 offen sc1
    buffer_load_dwordx4 v[236:239], v36, s[72:75], 0 offen sc1
    s_waitcnt vmcnt(0)
    v_xor_b32 v224, v233, v37
    v_xor_b32 v225, v235, v37
    v_xor_b32 v226, v237, v38
    v_xor_b32 v227, v239, v38
    v_or3_b32 v224, v224, v225, v226
    v_or_b32 v224, v224, v227
    v_cmp_ne_u32 vcc, 0, v224
    s_nop 1
    s_cbranch_vccnz SLOW_S
    s_branch BACK_S
SLOW_G:
    s_cmp_eq_u32 s96, 0
    s_cbranch_scc1 BACK_G
    s_sub_u32 s96, s96, 1
    s_sleep 1
    buffer_load_dwordx2 v[160:161], v39, s[72:75], 0 offen sc1
    s_waitcnt vmcnt(0)
    v_cmp_ne_u32 vcc, v161, v59
    s_nop 1
    s_cbranch_vccnz SLOW_G
    s_branch BACK_G
SLOW_P:
    s_cmp_eq_u32 s96, 0
    s_cbranch_scc1 BACK_P
    s_sub_u32 s96, s96, 1
    s_sleep 1
    buffer_load_dwordx4 v[208:211], v169, s[72:75], 0 offen offset:0 sc1
    buffer_load_dwordx4 v[212:215], v169, s[72:75], 0 offen offset:1024 sc1
    buffer_load_dwordx4 v[216:219], v169, s[72:75], 0 offen offset:2048 sc1
    buffer_load_dwordx4 v[220:223], v169, s[72:75], 0 offen offset:3072 sc1
    s_waitcnt vmcnt(0)
    v_xor_b32 v224, v208, v59
    v_xor_b32 v225, v212, v59
    v_xor_b32 v226, v216, v59
    v_xor_b32 v227, v220, v59
    v_or3_b32 v224, v224, v225, v226
    v_or_b32 v224, v224, v227
    v_and_b32 v224, s41, v224
    v_cmp_ne_u32 vcc, 0, v224
    s_nop 1
    s_cbranch_vccnz SLOW_P
    s_branch BACK_P
SLOW_F0:
    s_cmp_eq_u32 s96, 0
    s_cbranch_scc1 BACK_F0
    s_sub_u32 s96, s96, 1
    s_sleep 1
    buffer_load_dword v60, v33, s[72:75], 0 offen offset:0 sc1
    s_waitcnt vmcnt(0)
    v_cmp_ne_u32 vcc, v60, v59
    s_nop 1
    s_cbranch_vccnz SLOW_F0
    s_branch BACK_F0
SLOW_F1:
    s_cmp_eq_u32 s96, 0
    s_cbranch_scc1 BACK_F1
    s_sub_u32 s96, s96, 1
    s_sleep 1
    buffer_load_dword v60, v33, s[72:75], 0 offen offset:256 sc1
    s_waitcnt vmcnt(0)
    v_cmp_ne_u32 vcc, v60, v59
    s_nop 1
    s_cbranch_vccnz SLOW_F1
    s_branch BACK_F1
SLOW_F2:
    s_cmp_eq_u32 s96, 0
    s_cbranch_scc1 BACK_F2
    s_sub_u32 s96, s96, 1
    s_sleep 1
    buffer_load_dword v60, v33, s[72:75], 0 offen offset:128 sc1
    s_waitcnt vmcnt(0)
    v_cmp_ne_u32 vcc, v60, v59
    s_nop 1
    s_cbranch_vccnz SLOW_F2
    s_branch BACK_F2
L_HELPER:
    s_sub_u32 s6, s6, 28
    s_add_u32 s3, s3, s6
    s_lshl_b32 s3, s3, 1
    s_add_u32 s3, s3, s83
    s_lshl_b32 s3, s3, 2
    s_add_u32 s3, s3, s43
    s_lshl_b32 s97, s3, 4
    v_mov_b32 v3, 0x40000000
    v_lshlrev_b32 v2, 4, v1
    v_cmp_gt_u32 vcc, 56, v1
    s_mul_i32 s3, s97, 896
    s_nop 0
    v_cndmask_b32 v2, v3, v2, vcc
    s_waitcnt lgkmcnt(0)
    s_load_dword s42, s[72:73], 0
    s_load_dwordx2 s[68:69], s[0:1], 104
    s_load_dwordx2 s[56:57], s[0:1], 24
    s_load_dwordx2 s[60:61], s[0:1], 32
    s_load_dwordx2 s[64:65], s[0:1], 96
    s_load_dwordx2 s[8:9], s[0:1], 40
    s_load_dwordx2 s[12:13], s[0:1], 48
    s_lshl_b32 s22, s6, 2
    s_add_u32 s22, s22, s43
    v_lshlrev_b32 v40, 7, v1
    v_mul_u32_u24 v41, 3584, v1
    s_mul_i32 s23, s83, 200704
    s_mul_i32 s24, s83, 1792
    s_bfe_u32 s34, s2, 0x20001
    s_mul_i32 s31, s83, 802816
    s_mul_i32 s32, s83, 384
    v_mul_u32_u24 v43, 896, v1
    s_lshr_b32 s29, s97, 7
    s_mul_i32 s29, s29, 114688
    s_mul_i32 s30, s6, 2
    s_waitcnt lgkmcnt(0)
    s_mov_b32 s46, 1835008
    s_mov_b32 s47, 0x20000
    s_mov_b32 s70, 896
    s_mov_b32 s71, 0x20000
    s_mov_b32 s74, 15597568
    s_mov_b32 s75, 0x20000
    s_mov_b32 s58, 401408
    s_mov_b32 s59, 0x20000
    s_mov_b32 s62, 401408
    s_mov_b32 s63, 0x20000
    s_mov_b32 s66, 1605632
    s_mov_b32 s67, 0x20000
    s_mov_b32 s10, 401408
    s_mov_b32 s11, 0x20000
    s_mov_b32 s14, 401408
    s_mov_b32 s15, 0x20000
    s_mov_b32 s50, 1605632
    s_mov_b32 s51, 0x20000
    s_mov_b32 s54, 1605632
    s_mov_b32 s55, 0x20000
    s_add_u32 s26, s43, 0
    s_lshr_b32 s27, s26, 1
    s_add_u32 s27, s27, s30
    s_add_u32 s27, s27, 2
    s_mul_i32 s28, s27, 37
    s_lshr_b32 s28, s28, 8
    s_mul_i32 s28, s28, 7
    s_sub_u32 s27, s27, s28
    s_lshl_b32 s25, s27, 7
    s_and_b32 s28, s26, 1
    s_mul_i32 s28, s28, 57344
    s_add_u32 s25, s25, s28
    s_add_u32 s25, s25, s29
    s_cmp_lt_u32 s26, 10
    s_cselect_b32 s25, s25, 0x40000000
    buffer_load_dword v42, v43, s[44:47], s25 offen
    s_add_u32 s26, s43, 4
    s_lshr_b32 s27, s26, 1
    s_add_u32 s27, s27, s30
    s_add_u32 s27, s27, 2
    s_mul_i32 s28, s27, 37
    s_lshr_b32 s28, s28, 8
    s_mul_i32 s28, s28, 7
    s_sub_u32 s27, s27, s28
    s_lshl_b32 s25, s27, 7
    s_and_b32 s28, s26, 1
    s_mul_i32 s28, s28, 57344
    s_add_u32 s25, s25, s28
    s_add_u32 s25, s25, s29
    s_cmp_lt_u32 s26, 10
    s_cselect_b32 s25, s25, 0x40000000
    buffer_load_dword v42, v43, s[44:47], s25 offen
    s_add_u32 s26, s43, 8
    s_lshr_b32 s27, s26, 1
    s_add_u32 s27, s27, s30
    s_add_u32 s27, s27, 2
    s_mul_i32 s28, s27, 37
    s_lshr_b32 s28, s28, 8
    s_mul_i32 s28, s28, 7
    s_sub_u32 s27, s27, s28
    s_lshl_b32 s25, s27, 7
    s_and_b32 s28, s26, 1
    s_mul_i32 s28, s28, 57344
    s_add_u32 s25, s25, s28
    s_add_u32 s25, s25, s29
    s_cmp_lt_u32 s26, 10
    s_cselect_b32 s25, s25, 0x40000000
    buffer_load_dword v42, v43, s[44:47], s25 offen
    s_add_u32 s33, s22, 0
    s_mul_i32 s26, s34, 6
    s_add_u32 s26, s26, s33
    s_cmp_ge_u32 s26, 25
    s_cselect_b32 s35, 25, 0
    s_sub_u32 s26, s26, s35
    s_lshl_b32 s25, s26, 13
    s_add_u32 s25, s25, s23
    s_cmp_lt_u32 s33, 25
    s_cselect_b32 s25, s25, 0x40000000
    buffer_load_dword v42, v40, s[56:59], s25 offen
    s_add_u32 s33, s22, 16
    s_mul_i32 s26, s34, 6
    s_add_u32 s26, s26, s33
    s_cmp_ge_u32 s26, 25
    s_cselect_b32 s35, 25, 0
    s_sub_u32 s26, s26, s35
    s_lshl_b32 s25, s26, 13
    s_add_u32 s25, s25, s23
    s_cmp_lt_u32 s33, 25
    s_cselect_b32 s25, s25, 0x40000000
    buffer_load_dword v42, v40, s[56:59], s25 offen
    s_add_u32 s33, s22, 0
    s_mul_i32 s26, s34, 6
    s_add_u32 s26, s26, s33
    s_cmp_ge_u32 s26, 25
    s_cselect_b32 s35, 25, 0
    s_sub_u32 s26, s26, s35
    s_lshl_b32 s25, s26, 13
    s_add_u32 s25, s25, s23
    s_cmp_lt_u32 s33, 25
    s_cselect_b32 s25, s25, 0x40000000
    buffer_load_dword v42, v40, s[60:63], s25 offen
    s_add_u32 s33, s22, 16
    s_mul_i32 s26, s34, 6
    s_add_u32 s26, s26, s33
    s_cmp_ge_u32 s26, 25
    s_cselect_b32 s35, 25, 0
    s_sub_u32 s26, s26, s35
    s_lshl_b32 s25, s26, 13
    s_add_u32 s25, s25, s23
    s_cmp_lt_u32 s33, 25
    s_cselect_b32 s25, s25, 0x40000000
    buffer_load_dword v42, v40, s[60:63], s25 offen
    buffer_load_dwordx4 v[64:67], v2, s[44:47], s3 offen offset:0
    buffer_load_dwordx4 v[68:71], v2, s[44:47], s3 offen offset:896
    buffer_load_dwordx4 v[72:75], v2, s[44:47], s3 offen offset:1792
    buffer_load_dwordx4 v[76:79], v2, s[44:47], s3 offen offset:2688
    s_add_u32 s3, s3, 3584
    buffer_load_dwordx4 v[80:83], v2, s[44:47], s3 offen offset:0
    buffer_load_dwordx4 v[84:87], v2, s[44:47], s3 offen offset:896
    buffer_load_dwordx4 v[88:91], v2, s[44:47], s3 offen offset:1792
    buffer_load_dwordx4 v[92:95], v2, s[44:47], s3 offen offset:2688
    s_add_u32 s3, s3, 3584
    buffer_load_dwordx4 v[96:99], v2, s[44:47], s3 offen offset:0
    buffer_load_dwordx4 v[100:103], v2, s[44:47], s3 offen offset:896
    buffer_load_dwordx4 v[104:107], v2, s[44:47], s3 offen offset:1792
    buffer_load_dwordx4 v[108:111], v2, s[44:47], s3 offen offset:2688
    s_add_u32 s3, s3, 3584
    buffer_load_dwordx4 v[112:115], v2, s[44:47], s3 offen offset:0
    buffer_load_dwordx4 v[116:119], v2, s[44:47], s3 offen offset:896
    buffer_load_dwordx4 v[120:123], v2, s[44:47], s3 offen offset:1792
    buffer_load_dwordx4 v[124:127], v2, s[44:47], s3 offen offset:2688
    s_add_u32 s3, s3, 3584
    buffer_load_dwordx4 v[4:7], v2, s[68:71], 0 offen
    s_add_u32 s33, s22, 0
    s_mul_i32 s26, s34, 12
    s_add_u32 s26, s26, s33
    s_cmp_ge_u32 s26, 49
    s_cselect_b32 s35, 49, 0
    s_sub_u32 s26, s26, s35
    s_mul_i32 s27, s26, 147
    s_lshr_b32 s27, s27, 10
    s_mul_i32 s28, s27, 7
    s_sub_u32 s28, s26, s28
    s_mul_i32 s25, s27, 229376
    s_lshl_b32 s28, s28, 8
    s_add_u32 s25, s25, s28
    s_add_u32 s25, s25, s24
    s_add_u32 s25, s25, 128
    s_cmp_lt_u32 s33, 49
    s_cselect_b32 s25, s25, 0x40000000
    buffer_load_dword v42, v41, s[48:51], s25 offen
    s_waitcnt vmcnt(1)
    v_lshlrev_b32 v8, 16, v4
    v_and_b32 v9, 0xffff0000, v4
    v_lshlrev_b32 v10, 16, v5
    v_and_b32 v11, 0xffff0000, v5
    v_lshlrev_b32 v12, 16, v6
    v_and_b32 v13, 0xffff0000, v6
    v_lshlrev_b32 v14, 16, v7
    v_and_b32 v15, 0xffff0000, v7
    v_mov_b32 v16, 0
    s_add_u32 s33, s22, 16
    s_mul_i32 s26, s34, 12
    s_add_u32 s26, s26, s33
    s_cmp_ge_u32 s26, 49
    s_cselect_b32 s35, 49, 0
    s_sub_u32 s26, s26, s35
    s_mul_i32 s27, s26, 147
    s_lshr_b32 s27, s27, 10
    s_mul_i32 s28, s27, 7
    s_sub_u32 s28, s26, s28
    s_mul_i32 s25, s27, 229376
    s_lshl_b32 s28, s28, 8
    s_add_u32 s25, s25, s28
    s_add_u32 s25, s25, s24
    s_add_u32 s25, s25, 128
    s_cmp_lt_u32 s33, 49
    s_cselect_b32 s25, s25, 0x40000000
    buffer_load_dword v42, v41, s[48:51], s25 offen
    v_lshlrev_b32 v20, 16, v64
    v_and_b32 v21, 0xffff0000, v64
    v_lshlrev_b32 v22, 16, v65
    v_and_b32 v23, 0xffff0000, v65
    v_lshlrev_b32 v24, 16, v66
    v_and_b32 v25, 0xffff0000, v66
    v_lshlrev_b32 v26, 16, v67
    v_and_b32 v27, 0xffff0000, v67
    v_mul_f32 v20, v20, v8
    v_mul_f32 v21, v21, v9
    v_mul_f32 v22, v22, v10
    v_mul_f32 v23, v23, v11
    v_mul_f32 v24, v24, v12
    v_mul_f32 v25, v25, v13
    v_mul_f32 v26, v26, v14
    v_mul_f32 v27, v27, v15
    v_cvt_pk_bf16_f32 v28, v20, v21
    v_cvt_pk_bf16_f32 v29, v22, v23
    v_cvt_pk_bf16_f32 v30, v24, v25
    v_cvt_pk_bf16_f32 v31, v26, v27
    v_lshlrev_b32 v20, 16, v28
    v_and_b32 v21, 0xffff0000, v28
    v_lshlrev_b32 v22, 16, v29
    v_and_b32 v23, 0xffff0000, v29
    v_lshlrev_b32 v24, 16, v30
    v_and_b32 v25, 0xffff0000, v30
    v_lshlrev_b32 v26, 16, v31
    v_and_b32 v27, 0xffff0000, v31
    v_add_f32 v20, v20, v21
    v_add_f32 v22, v22, v23
    v_add_f32 v24, v24, v25
    v_add_f32 v26, v26, v27
    v_add_f32 v20, v20, v22
    v_add_f32 v24, v24, v26
    v_add_f32 v20, v20, v24
    s_nop 1
    v_add_f32_dpp v20, v20, v20 row_shr:1 row_mask:0xf bank_mask:0xf bound_ctrl:0
    s_nop 1
    v_add_f32_dpp v20, v20, v20 row_shr:2 row_mask:0xf bank_mask:0xf bound_ctrl:0
    s_nop 1
    v_add_f32_dpp v20, v20, v20 row_shr:4 row_mask:0xf bank_mask:0xf bound_ctrl:0
    s_nop 1
    v_add_f32_dpp v20, v20, v20 row_shr:8 row_mask:0xf bank_mask:0xf bound_ctrl:0
    s_nop 1
    v_add_f32_dpp v20, v20, v20 row_bcast:15 row_mask:0xa bank_mask:0xf
    s_nop 1
    v_add_f32_dpp v20, v20, v20 row_bcast:31 row_mask:0xc bank_mask:0xf
    s_nop 0
    v_readlane_b32 s4, v20, 63
    s_nop 3
    v_writelane_b32 v16, s4, 0
    v_lshlrev_b32 v20, 16, v68
    v_and_b32 v21, 0xffff0000, v68
    v_lshlrev_b32 v22, 16, v69
    v_and_b32 v23, 0xffff0000, v69
    v_lshlrev_b32 v24, 16, v70
    v_and_b32 v25, 0xffff0000, v70
    v_lshlrev_b32 v26, 16, v71
    v_and_b32 v27, 0xffff0000, v71
    v_mul_f32 v20, v20, v8
    v_mul_f32 v21, v21, v9
    v_mul_f32 v22, v22, v10
    v_mul_f32 v23, v23, v11
    v_mul_f32 v24, v24, v12
    v_mul_f32 v25, v25, v13
    v_mul_f32 v26, v26, v14
    v_mul_f32 v27, v27, v15
    v_cvt_pk_bf16_f32 v28, v20, v21
    v_cvt_pk_bf16_f32 v29, v22, v23
    v_cvt_pk_bf16_f32 v30, v24, v25
    v_cvt_pk_bf16_f32 v31, v26, v27
    v_lshlrev_b32 v20, 16, v28
    v_and_b32 v21, 0xffff0000, v28
    v_lshlrev_b32 v22, 16, v29
    v_and_b32 v23, 0xffff0000, v29
    v_lshlrev_b32 v24, 16, v30
    v_and_b32 v25, 0xffff0000, v30
    v_lshlrev_b32 v26, 16, v31
    v_and_b32 v27, 0xffff0000, v31
    v_add_f32 v20, v20, v21
    v_add_f32 v22, v22, v23
    v_add_f32 v24, v24, v25
    v_add_f32 v26, v26, v27
    v_add_f32 v20, v20, v22
    v_add_f32 v24, v24, v26
    v_add_f32 v20, v20, v24
    s_nop 1
    v_add_f32_dpp v20, v20, v20 row_shr:1 row_mask:0xf bank_mask:0xf bound_ctrl:0
    s_nop 1
    v_add_f32_dpp v20, v20, v20 row_shr:2 row_mask:0xf bank_mask:0xf bound_ctrl:0
    s_nop 1
    v_add_f32_dpp v20, v20, v20 row_shr:4 row_mask:0xf bank_mask:0xf bound_ctrl:0
    s_nop 1
    v_add_f32_dpp v20, v20, v20 row_shr:8 row_mask:0xf bank_mask:0xf bound_ctrl:0
    s_nop 1
    v_add_f32_dpp v20, v20, v20 row_bcast:15 row_mask:0xa bank_mask:0xf
    s_nop 1
    v_add_f32_dpp v20, v20, v20 row_bcast:31 row_mask:0xc bank_mask:0xf
    s_nop 0
    v_readlane_b32 s4, v20, 63
    s_nop 3
    v_writelane_b32 v16, s4, 1
    s_add_u32 s33, s22, 32
    s_mul_i32 s26, s34, 12
    s_add_u32 s26, s26, s33
    s_cmp_ge_u32 s26, 49
    s_cselect_b32 s35, 49, 0
    s_sub_u32 s26, s26, s35
    s_mul_i32 s27, s26, 147
    s_lshr_b32 s27, s27, 10
    s_mul_i32 s28, s27, 7
    s_sub_u32 s28, s26, s28
    s_mul_i32 s25, s27, 229376
    s_lshl_b32 s28, s28, 8
    s_add_u32 s25, s25, s28
    s_add_u32 s25, s25, s24
    s_add_u32 s25, s25, 128
    s_cmp_lt_u32 s33, 49
    s_cselect_b32 s25, s25, 0x40000000
    buffer_load_dword v42, v41, s[48:51], s25 offen
    v_lshlrev_b32 v20, 16, v72
    v_and_b32 v21, 0xffff0000, v72
    v_lshlrev_b32 v22, 16, v73
    v_and_b32 v23, 0xffff0000, v73
    v_lshlrev_b32 v24, 16, v74
    v_and_b32 v25, 0xffff0000, v74
    v_lshlrev_b32 v26, 16, v75
    v_and_b32 v27, 0xffff0000, v75
    v_mul_f32 v20, v20, v8
    v_mul_f32 v21, v21, v9
    v_mul_f32 v22, v22, v10
    v_mul_f32 v23, v23, v11
    v_mul_f32 v24, v24, v12
    v_mul_f32 v25, v25, v13
    v_mul_f32 v26, v26, v14
    v_mul_f32 v27, v27, v15
    v_cvt_pk_bf16_f32 v28, v20, v21
    v_cvt_pk_bf16_f32 v29, v22, v23
    v_cvt_pk_bf16_f32 v30, v24, v25
    v_cvt_pk_bf16_f32 v31, v26, v27
    v_lshlrev_b32 v20, 16, v28
    v_and_b32 v21, 0xffff0000, v28
    v_lshlrev_b32 v22, 16, v29
    v_and_b32 v23, 0xffff0000, v29
    v_lshlrev_b32 v24, 16, v30
    v_and_b32 v25, 0xffff0000, v30
    v_lshlrev_b32 v26, 16, v31
    v_and_b32 v27, 0xffff0000, v31
    v_add_f32 v20, v20, v21
    v_add_f32 v22, v22, v23
    v_add_f32 v24, v24, v25
    v_add_f32 v26, v26, v27
    v_add_f32 v20, v20, v22
    v_add_f32 v24, v24, v26
    v_add_f32 v20, v20, v24
    s_nop 1
    v_add_f32_dpp v20, v20, v20 row_shr:1 row_mask:0xf bank_mask:0xf bound_ctrl:0
    s_nop 1
    v_add_f32_dpp v20, v20, v20 row_shr:2 row_mask:0xf bank_mask:0xf bound_ctrl:0
    s_nop 1
    v_add_f32_dpp v20, v20, v20 row_shr:4 row_mask:0xf bank_mask:0xf bound_ctrl:0
    s_nop 1
    v_add_f32_dpp v20, v20, v20 row_shr:8 row_mask:0xf bank_mask:0xf bound_ctrl:0
    s_nop 1
    v_add_f32_dpp v20, v20, v20 row_bcast:15 row_mask:0xa bank_mask:0xf
    s_nop 1
    v_add_f32_dpp v20, v20, v20 row_bcast:31 row_mask:0xc bank_mask:0xf
    s_nop 0
    v_readlane_b32 s4, v20, 63
    s_nop 3
    v_writelane_b32 v16, s4, 2
    v_lshlrev_b32 v20, 16, v76
    v_and_b32 v21, 0xffff0000, v76
    v_lshlrev_b32 v22, 16, v77
    v_and_b32 v23, 0xffff0000, v77
    v_lshlrev_b32 v24, 16, v78
    v_and_b32 v25, 0xffff0000, v78
    v_lshlrev_b32 v26, 16, v79
    v_and_b32 v27, 0xffff0000, v79
    v_mul_f32 v20, v20, v8
    v_mul_f32 v21, v21, v9
    v_mul_f32 v22, v22, v10
    v_mul_f32 v23, v23, v11
    v_mul_f32 v24, v24, v12
    v_mul_f32 v25, v25, v13
    v_mul_f32 v26, v26, v14
    v_mul_f32 v27, v27, v15
    v_cvt_pk_bf16_f32 v28, v20, v21
    v_cvt_pk_bf16_f32 v29, v22, v23
    v_cvt_pk_bf16_f32 v30, v24, v25
    v_cvt_pk_bf16_f32 v31, v26, v27
    v_lshlrev_b32 v20, 16, v28
    v_and_b32 v21, 0xffff0000, v28
    v_lshlrev_b32 v22, 16, v29
    v_and_b32 v23, 0xffff0000, v29
    v_lshlrev_b32 v24, 16, v30
    v_and_b32 v25, 0xffff0000, v30
    v_lshlrev_b32 v26, 16, v31
    v_and_b32 v27, 0xffff0000, v31
    v_add_f32 v20, v20, v21
    v_add_f32 v22, v22, v23
    v_add_f32 v24, v24, v25
    v_add_f32 v26, v26, v27
    v_add_f32 v20, v20, v22
    v_add_f32 v24, v24, v26
    v_add_f32 v20, v20, v24
    s_nop 1
    v_add_f32_dpp v20, v20, v20 row_shr:1 row_mask:0xf bank_mask:0xf bound_ctrl:0
    s_nop 1
    v_add_f32_dpp v20, v20, v20 row_shr:2 row_mask:0xf bank_mask:0xf bound_ctrl:0
    s_nop 1
    v_add_f32_dpp v20, v20, v20 row_shr:4 row_mask:0xf bank_mask:0xf bound_ctrl:0
    s_nop 1
    v_add_f32_dpp v20, v20, v20 row_shr:8 row_mask:0xf bank_mask:0xf bound_ctrl:0
    s_nop 1
    v_add_f32_dpp v20, v20, v20 row_bcast:15 row_mask:0xa bank_mask:0xf
    s_nop 1
    v_add_f32_dpp v20, v20, v20 row_bcast:31 row_mask:0xc bank_mask:0xf
    s_nop 0
    v_readlane_b32 s4, v20, 63
    s_nop 3
    v_writelane_b32 v16, s4, 3
    s_add_u32 s33, s22, 48
    s_mul_i32 s26, s34, 12
    s_add_u32 s26, s26, s33
    s_cmp_ge_u32 s26, 49
    s_cselect_b32 s35, 49, 0
    s_sub_u32 s26, s26, s35
    s_mul_i32 s27, s26, 147
    s_lshr_b32 s27, s27, 10
    s_mul_i32 s28, s27, 7
    s_sub_u32 s28, s26, s28
    s_mul_i32 s25, s27, 229376
    s_lshl_b32 s28, s28, 8
    s_add_u32 s25, s25, s28
    s_add_u32 s25, s25, s24
    s_add_u32 s25, s25, 128
    s_cmp_lt_u32 s33, 49
    s_cselect_b32 s25, s25, 0x40000000
    buffer_load_dword v42, v41, s[48:51], s25 offen
    v_lshlrev_b32 v20, 16, v80
    v_and_b32 v21, 0xffff0000, v80
    v_lshlrev_b32 v22, 16, v81
    v_and_b32 v23, 0xffff0000, v81
    v_lshlrev_b32 v24, 16, v82
    v_and_b32 v25, 0xffff0000, v82
    v_lshlrev_b32 v26, 16, v83
    v_and_b32 v27, 0xffff0000, v83
    v_mul_f32 v20, v20, v8
    v_mul_f32 v21, v21, v9
    v_mul_f32 v22, v22, v10
    v_mul_f32 v23, v23, v11
    v_mul_f32 v24, v24, v12
    v_mul_f32 v25, v25, v13
    v_mul_f32 v26, v26, v14
    v_mul_f32 v27, v27, v15
    v_cvt_pk_bf16_f32 v28, v20, v21
    v_cvt_pk_bf16_f32 v29, v22, v23
    v_cvt_pk_bf16_f32 v30, v24, v25
    v_cvt_pk_bf16_f32 v31, v26, v27
    v_lshlrev_b32 v20, 16, v28
    v_and_b32 v21, 0xffff0000, v28
    v_lshlrev_b32 v22, 16, v29
    v_and_b32 v23, 0xffff0000, v29
    v_lshlrev_b32 v24, 16, v30
    v_and_b32 v25, 0xffff0000, v30
    v_lshlrev_b32 v26, 16, v31
    v_and_b32 v27, 0xffff0000, v31
    v_add_f32 v20, v20, v21
    v_add_f32 v22, v22, v23
    v_add_f32 v24, v24, v25
    v_add_f32 v26, v26, v27
    v_add_f32 v20, v20, v22
    v_add_f32 v24, v24, v26
    v_add_f32 v20, v20, v24
    s_nop 1
    v_add_f32_dpp v20, v20, v20 row_shr:1 row_mask:0xf bank_mask:0xf bound_ctrl:0
    s_nop 1
    v_add_f32_dpp v20, v20, v20 row_shr:2 row_mask:0xf bank_mask:0xf bound_ctrl:0
    s_nop 1
    v_add_f32_dpp v20, v20, v20 row_shr:4 row_mask:0xf bank_mask:0xf bound_ctrl:0
    s_nop 1
    v_add_f32_dpp v20, v20, v20 row_shr:8 row_mask:0xf bank_mask:0xf bound_ctrl:0
    s_nop 1
    v_add_f32_dpp v20, v20, v20 row_bcast:15 row_mask:0xa bank_mask:0xf
    s_nop 1
    v_add_f32_dpp v20, v20, v20 row_bcast:31 row_mask:0xc bank_mask:0xf
    s_nop 0
    v_readlane_b32 s4, v20, 63
    s_nop 3
    v_writelane_b32 v16, s4, 4
    v_lshlrev_b32 v20, 16, v84
    v_and_b32 v21, 0xffff0000, v84
    v_lshlrev_b32 v22, 16, v85
    v_and_b32 v23, 0xffff0000, v85
    v_lshlrev_b32 v24, 16, v86
    v_and_b32 v25, 0xffff0000, v86
    v_lshlrev_b32 v26, 16, v87
    v_and_b32 v27, 0xffff0000, v87
    v_mul_f32 v20, v20, v8
    v_mul_f32 v21, v21, v9
    v_mul_f32 v22, v22, v10
    v_mul_f32 v23, v23, v11
    v_mul_f32 v24, v24, v12
    v_mul_f32 v25, v25, v13
    v_mul_f32 v26, v26, v14
    v_mul_f32 v27, v27, v15
    v_cvt_pk_bf16_f32 v28, v20, v21
    v_cvt_pk_bf16_f32 v29, v22, v23
    v_cvt_pk_bf16_f32 v30, v24, v25
    v_cvt_pk_bf16_f32 v31, v26, v27
    v_lshlrev_b32 v20, 16, v28
    v_and_b32 v21, 0xffff0000, v28
    v_lshlrev_b32 v22, 16, v29
    v_and_b32 v23, 0xffff0000, v29
    v_lshlrev_b32 v24, 16, v30
    v_and_b32 v25, 0xffff0000, v30
    v_lshlrev_b32 v26, 16, v31
    v_and_b32 v27, 0xffff0000, v31
    v_add_f32 v20, v20, v21
    v_add_f32 v22, v22, v23
    v_add_f32 v24, v24, v25
    v_add_f32 v26, v26, v27
    v_add_f32 v20, v20, v22
    v_add_f32 v24, v24, v26
    v_add_f32 v20, v20, v24
    s_nop 1
    v_add_f32_dpp v20, v20, v20 row_shr:1 row_mask:0xf bank_mask:0xf bound_ctrl:0
    s_nop 1
    v_add_f32_dpp v20, v20, v20 row_shr:2 row_mask:0xf bank_mask:0xf bound_ctrl:0
    s_nop 1
    v_add_f32_dpp v20, v20, v20 row_shr:4 row_mask:0xf bank_mask:0xf bound_ctrl:0
    s_nop 1
    v_add_f32_dpp v20, v20, v20 row_shr:8 row_mask:0xf bank_mask:0xf bound_ctrl:0
    s_nop 1
    v_add_f32_dpp v20, v20, v20 row_bcast:15 row_mask:0xa bank_mask:0xf
    s_nop 1
    v_add_f32_dpp v20, v20, v20 row_bcast:31 row_mask:0xc bank_mask:0xf
    s_nop 0
    v_readlane_b32 s4, v20, 63
    s_nop 3
    v_writelane_b32 v16, s4, 5
    s_add_u32 s33, s22, 0
    s_mul_i32 s26, s34, 12
    s_add_u32 s26, s26, s33
    s_cmp_ge_u32 s26, 49
    s_cselect_b32 s35, 49, 0
    s_sub_u32 s26, s26, s35
    s_mul_i32 s27, s26, 147
    s_lshr_b32 s27, s27, 10
    s_mul_i32 s28, s27, 7
    s_sub_u32 s28, s26, s28
    s_mul_i32 s25, s27, 229376
    s_lshl_b32 s28, s28, 8
    s_add_u32 s25, s25, s28
    s_add_u32 s25, s25, s24
    s_add_u32 s25, s25, 128
    s_cmp_lt_u32 s33, 49
    s_cselect_b32 s25, s25, 0x40000000
    buffer_load_dword v42, v41, s[52:55], s25 offen
    v_lshlrev_b32 v20, 16, v88
    v_and_b32 v21, 0xffff0000, v88
    v_lshlrev_b32 v22, 16, v89
    v_and_b32 v23, 0xffff0000, v89
    v_lshlrev_b32 v24, 16, v90
    v_and_b32 v25, 0xffff0000, v90
    v_lshlrev_b32 v26, 16, v91
    v_and_b32 v27, 0xffff0000, v91
    v_mul_f32 v20, v20, v8
    v_mul_f32 v21, v21, v9
    v_mul_f32 v22, v22, v10
    v_mul_f32 v23, v23, v11
    v_mul_f32 v24, v24, v12
    v_mul_f32 v25, v25, v13
    v_mul_f32 v26, v26, v14
    v_mul_f32 v27, v27, v15
    v_cvt_pk_bf16_f32 v28, v20, v21
    v_cvt_pk_bf16_f32 v29, v22, v23
    v_cvt_pk_bf16_f32 v30, v24, v25
    v_cvt_pk_bf16_f32 v31, v26, v27
    v_lshlrev_b32 v20, 16, v28
    v_and_b32 v21, 0xffff0000, v28
    v_lshlrev_b32 v22, 16, v29
    v_and_b32 v23, 0xffff0000, v29
    v_lshlrev_b32 v24, 16, v30
    v_and_b32 v25, 0xffff0000, v30
    v_lshlrev_b32 v26, 16, v31
    v_and_b32 v27, 0xffff0000, v31
    v_add_f32 v20, v20, v21
    v_add_f32 v22, v22, v23
    v_add_f32 v24, v24, v25
    v_add_f32 v26, v26, v27
    v_add_f32 v20, v20, v22
    v_add_f32 v24, v24, v26
    v_add_f32 v20, v20, v24
    s_nop 1
    v_add_f32_dpp v20, v20, v20 row_shr:1 row_mask:0xf bank_mask:0xf bound_ctrl:0
    s_nop 1
    v_add_f32_dpp v20, v20, v20 row_shr:2 row_mask:0xf bank_mask:0xf bound_ctrl:0
    s_nop 1
    v_add_f32_dpp v20, v20, v20 row_shr:4 row_mask:0xf bank_mask:0xf bound_ctrl:0
    s_nop 1
    v_add_f32_dpp v20, v20, v20 row_shr:8 row_mask:0xf bank_mask:0xf bound_ctrl:0
    s_nop 1
    v_add_f32_dpp v20, v20, v20 row_bcast:15 row_mask:0xa bank_mask:0xf
    s_nop 1
    v_add_f32_dpp v20, v20, v20 row_bcast:31 row_mask:0xc bank_mask:0xf
    s_nop 0
    v_readlane_b32 s4, v20, 63
    s_nop 3
    v_writelane_b32 v16, s4, 6
    v_lshlrev_b32 v20, 16, v92
    v_and_b32 v21, 0xffff0000, v92
    v_lshlrev_b32 v22, 16, v93
    v_and_b32 v23, 0xffff0000, v93
    v_lshlrev_b32 v24, 16, v94
    v_and_b32 v25, 0xffff0000, v94
    v_lshlrev_b32 v26, 16, v95
    v_and_b32 v27, 0xffff0000, v95
    v_mul_f32 v20, v20, v8
    v_mul_f32 v21, v21, v9
    v_mul_f32 v22, v22, v10
    v_mul_f32 v23, v23, v11
    v_mul_f32 v24, v24, v12
    v_mul_f32 v25, v25, v13
    v_mul_f32 v26, v26, v14
    v_mul_f32 v27, v27, v15
    v_cvt_pk_bf16_f32 v28, v20, v21
    v_cvt_pk_bf16_f32 v29, v22, v23
    v_cvt_pk_bf16_f32 v30, v24, v25
    v_cvt_pk_bf16_f32 v31, v26, v27
    v_lshlrev_b32 v20, 16, v28
    v_and_b32 v21, 0xffff0000, v28
    v_lshlrev_b32 v22, 16, v29
    v_and_b32 v23, 0xffff0000, v29
    v_lshlrev_b32 v24, 16, v30
    v_and_b32 v25, 0xffff0000, v30
    v_lshlrev_b32 v26, 16, v31
    v_and_b32 v27, 0xffff0000, v31
    v_add_f32 v20, v20, v21
    v_add_f32 v22, v22, v23
    v_add_f32 v24, v24, v25
    v_add_f32 v26, v26, v27
    v_add_f32 v20, v20, v22
    v_add_f32 v24, v24, v26
    v_add_f32 v20, v20, v24
    s_nop 1
    v_add_f32_dpp v20, v20, v20 row_shr:1 row_mask:0xf bank_mask:0xf bound_ctrl:0
    s_nop 1
    v_add_f32_dpp v20, v20, v20 row_shr:2 row_mask:0xf bank_mask:0xf bound_ctrl:0
    s_nop 1
    v_add_f32_dpp v20, v20, v20 row_shr:4 row_mask:0xf bank_mask:0xf bound_ctrl:0
    s_nop 1
    v_add_f32_dpp v20, v20, v20 row_shr:8 row_mask:0xf bank_mask:0xf bound_ctrl:0
    s_nop 1
    v_add_f32_dpp v20, v20, v20 row_bcast:15 row_mask:0xa bank_mask:0xf
    s_nop 1
    v_add_f32_dpp v20, v20, v20 row_bcast:31 row_mask:0xc bank_mask:0xf
    s_nop 0
    v_readlane_b32 s4, v20, 63
    s_nop 3
    v_writelane_b32 v16, s4, 7
    s_add_u32 s33, s22, 16
    s_mul_i32 s26, s34, 12
    s_add_u32 s26, s26, s33
    s_cmp_ge_u32 s26, 49
    s_cselect_b32 s35, 49, 0
    s_sub_u32 s26, s26, s35
    s_mul_i32 s27, s26, 147
    s_lshr_b32 s27, s27, 10
    s_mul_i32 s28, s27, 7
    s_sub_u32 s28, s26, s28
    s_mul_i32 s25, s27, 229376
    s_lshl_b32 s28, s28, 8
    s_add_u32 s25, s25, s28
    s_add_u32 s25, s25, s24
    s_add_u32 s25, s25, 128
    s_cmp_lt_u32 s33, 49
    s_cselect_b32 s25, s25, 0x40000000
    buffer_load_dword v42, v41, s[52:55], s25 offen
    v_lshlrev_b32 v20, 16, v96
    v_and_b32 v21, 0xffff0000, v96
    v_lshlrev_b32 v22, 16, v97
    v_and_b32 v23, 0xffff0000, v97
    v_lshlrev_b32 v24, 16, v98
    v_and_b32 v25, 0xffff0000, v98
    v_lshlrev_b32 v26, 16, v99
    v_and_b32 v27, 0xffff0000, v99
    v_mul_f32 v20, v20, v8
    v_mul_f32 v21, v21, v9
    v_mul_f32 v22, v22, v10
    v_mul_f32 v23, v23, v11
    v_mul_f32 v24, v24, v12
    v_mul_f32 v25, v25, v13
    v_mul_f32 v26, v26, v14
    v_mul_f32 v27, v27, v15
    v_cvt_pk_bf16_f32 v28, v20, v21
    v_cvt_pk_bf16_f32 v29, v22, v23
    v_cvt_pk_bf16_f32 v30, v24, v25
    v_cvt_pk_bf16_f32 v31, v26, v27
    v_lshlrev_b32 v20, 16, v28
    v_and_b32 v21, 0xffff0000, v28
    v_lshlrev_b32 v22, 16, v29
    v_and_b32 v23, 0xffff0000, v29
    v_lshlrev_b32 v24, 16, v30
    v_and_b32 v25, 0xffff0000, v30
    v_lshlrev_b32 v26, 16, v31
    v_and_b32 v27, 0xffff0000, v31
    v_add_f32 v20, v20, v21
    v_add_f32 v22, v22, v23
    v_add_f32 v24, v24, v25
    v_add_f32 v26, v26, v27
    v_add_f32 v20, v20, v22
    v_add_f32 v24, v24, v26
    v_add_f32 v20, v20, v24
    s_nop 1
    v_add_f32_dpp v20, v20, v20 row_shr:1 row_mask:0xf bank_mask:0xf bound_ctrl:0
    s_nop 1
    v_add_f32_dpp v20, v20, v20 row_shr:2 row_mask:0xf bank_mask:0xf bound_ctrl:0
    s_nop 1
    v_add_f32_dpp v20, v20, v20 row_shr:4 row_mask:0xf bank_mask:0xf bound_ctrl:0
    s_nop 1
    v_add_f32_dpp v20, v20, v20 row_shr:8 row_mask:0xf bank_mask:0xf bound_ctrl:0
    s_nop 1
    v_add_f32_dpp v20, v20, v20 row_bcast:15 row_mask:0xa bank_mask:0xf
    s_nop 1
    v_add_f32_dpp v20, v20, v20 row_bcast:31 row_mask:0xc bank_mask:0xf
    s_nop 0
    v_readlane_b32 s4, v20, 63
    s_nop 3
    v_writelane_b32 v16, s4, 8
    v_lshlrev_b32 v20, 16, v100
    v_and_b32 v21, 0xffff0000, v100
    v_lshlrev_b32 v22, 16, v101
    v_and_b32 v23, 0xffff0000, v101
    v_lshlrev_b32 v24, 16, v102
    v_and_b32 v25, 0xffff0000, v102
    v_lshlrev_b32 v26, 16, v103
    v_and_b32 v27, 0xffff0000, v103
    v_mul_f32 v20, v20, v8
    v_mul_f32 v21, v21, v9
    v_mul_f32 v22, v22, v10
    v_mul_f32 v23, v23, v11
    v_mul_f32 v24, v24, v12
    v_mul_f32 v25, v25, v13
    v_mul_f32 v26, v26, v14
    v_mul_f32 v27, v27, v15
    v_cvt_pk_bf16_f32 v28, v20, v21
    v_cvt_pk_bf16_f32 v29, v22, v23
    v_cvt_pk_bf16_f32 v30, v24, v25
    v_cvt_pk_bf16_f32 v31, v26, v27
    v_lshlrev_b32 v20, 16, v28
    v_and_b32 v21, 0xffff0000, v28
    v_lshlrev_b32 v22, 16, v29
    v_and_b32 v23, 0xffff0000, v29
    v_lshlrev_b32 v24, 16, v30
    v_and_b32 v25, 0xffff0000, v30
    v_lshlrev_b32 v26, 16, v31
    v_and_b32 v27, 0xffff0000, v31
    v_add_f32 v20, v20, v21
    v_add_f32 v22, v22, v23
    v_add_f32 v24, v24, v25
    v_add_f32 v26, v26, v27
    v_add_f32 v20, v20, v22
    v_add_f32 v24, v24, v26
    v_add_f32 v20, v20, v24
    s_nop 1
    v_add_f32_dpp v20, v20, v20 row_shr:1 row_mask:0xf bank_mask:0xf bound_ctrl:0
    s_nop 1
    v_add_f32_dpp v20, v20, v20 row_shr:2 row_mask:0xf bank_mask:0xf bound_ctrl:0
    s_nop 1
    v_add_f32_dpp v20, v20, v20 row_shr:4 row_mask:0xf bank_mask:0xf bound_ctrl:0
    s_nop 1
    v_add_f32_dpp v20, v20, v20 row_shr:8 row_mask:0xf bank_mask:0xf bound_ctrl:0
    s_nop 1
    v_add_f32_dpp v20, v20, v20 row_bcast:15 row_mask:0xa bank_mask:0xf
    s_nop 1
    v_add_f32_dpp v20, v20, v20 row_bcast:31 row_mask:0xc bank_mask:0xf
    s_nop 0
    v_readlane_b32 s4, v20, 63
    s_nop 3
    v_writelane_b32 v16, s4, 9
    s_add_u32 s33, s22, 32
    s_mul_i32 s26, s34, 12
    s_add_u32 s26, s26, s33
    s_cmp_ge_u32 s26, 49
    s_cselect_b32 s35, 49, 0
    s_sub_u32 s26, s26, s35
    s_mul_i32 s27, s26, 147
    s_lshr_b32 s27, s27, 10
    s_mul_i32 s28, s27, 7
    s_sub_u32 s28, s26, s28
    s_mul_i32 s25, s27, 229376
    s_lshl_b32 s28, s28, 8
    s_add_u32 s25, s25, s28
    s_add_u32 s25, s25, s24
    s_add_u32 s25, s25, 128
    s_cmp_lt_u32 s33, 49
    s_cselect_b32 s25, s25, 0x40000000
    buffer_load_dword v42, v41, s[52:55], s25 offen
    v_lshlrev_b32 v20, 16, v104
    v_and_b32 v21, 0xffff0000, v104
    v_lshlrev_b32 v22, 16, v105
    v_and_b32 v23, 0xffff0000, v105
    v_lshlrev_b32 v24, 16, v106
    v_and_b32 v25, 0xffff0000, v106
    v_lshlrev_b32 v26, 16, v107
    v_and_b32 v27, 0xffff0000, v107
    v_mul_f32 v20, v20, v8
    v_mul_f32 v21, v21, v9
    v_mul_f32 v22, v22, v10
    v_mul_f32 v23, v23, v11
    v_mul_f32 v24, v24, v12
    v_mul_f32 v25, v25, v13
    v_mul_f32 v26, v26, v14
    v_mul_f32 v27, v27, v15
    v_cvt_pk_bf16_f32 v28, v20, v21
    v_cvt_pk_bf16_f32 v29, v22, v23
    v_cvt_pk_bf16_f32 v30, v24, v25
    v_cvt_pk_bf16_f32 v31, v26, v27
    v_lshlrev_b32 v20, 16, v28
    v_and_b32 v21, 0xffff0000, v28
    v_lshlrev_b32 v22, 16, v29
    v_and_b32 v23, 0xffff0000, v29
    v_lshlrev_b32 v24, 16, v30
    v_and_b32 v25, 0xffff0000, v30
    v_lshlrev_b32 v26, 16, v31
    v_and_b32 v27, 0xffff0000, v31
    v_add_f32 v20, v20, v21
    v_add_f32 v22, v22, v23
    v_add_f32 v24, v24, v25
    v_add_f32 v26, v26, v27
    v_add_f32 v20, v20, v22
    v_add_f32 v24, v24, v26
    v_add_f32 v20, v20, v24
    s_nop 1
    v_add_f32_dpp v20, v20, v20 row_shr:1 row_mask:0xf bank_mask:0xf bound_ctrl:0
    s_nop 1
    v_add_f32_dpp v20, v20, v20 row_shr:2 row_mask:0xf bank_mask:0xf bound_ctrl:0
    s_nop 1
    v_add_f32_dpp v20, v20, v20 row_shr:4 row_mask:0xf bank_mask:0xf bound_ctrl:0
    s_nop 1
    v_add_f32_dpp v20, v20, v20 row_shr:8 row_mask:0xf bank_mask:0xf bound_ctrl:0
    s_nop 1
    v_add_f32_dpp v20, v20, v20 row_bcast:15 row_mask:0xa bank_mask:0xf
    s_nop 1
    v_add_f32_dpp v20, v20, v20 row_bcast:31 row_mask:0xc bank_mask:0xf
    s_nop 0
    v_readlane_b32 s4, v20, 63
    s_nop 3
    v_writelane_b32 v16, s4, 10
    v_lshlrev_b32 v20, 16, v108
    v_and_b32 v21, 0xffff0000, v108
    v_lshlrev_b32 v22, 16, v109
    v_and_b32 v23, 0xffff0000, v109
    v_lshlrev_b32 v24, 16, v110
    v_and_b32 v25, 0xffff0000, v110
    v_lshlrev_b32 v26, 16, v111
    v_and_b32 v27, 0xffff0000, v111
    v_mul_f32 v20, v20, v8
    v_mul_f32 v21, v21, v9
    v_mul_f32 v22, v22, v10
    v_mul_f32 v23, v23, v11
    v_mul_f32 v24, v24, v12
    v_mul_f32 v25, v25, v13
    v_mul_f32 v26, v26, v14
    v_mul_f32 v27, v27, v15
    v_cvt_pk_bf16_f32 v28, v20, v21
    v_cvt_pk_bf16_f32 v29, v22, v23
    v_cvt_pk_bf16_f32 v30, v24, v25
    v_cvt_pk_bf16_f32 v31, v26, v27
    v_lshlrev_b32 v20, 16, v28
    v_and_b32 v21, 0xffff0000, v28
    v_lshlrev_b32 v22, 16, v29
    v_and_b32 v23, 0xffff0000, v29
    v_lshlrev_b32 v24, 16, v30
    v_and_b32 v25, 0xffff0000, v30
    v_lshlrev_b32 v26, 16, v31
    v_and_b32 v27, 0xffff0000, v31
    v_add_f32 v20, v20, v21
    v_add_f32 v22, v22, v23
    v_add_f32 v24, v24, v25
    v_add_f32 v26, v26, v27
    v_add_f32 v20, v20, v22
    v_add_f32 v24, v24, v26
    v_add_f32 v20, v20, v24
    s_nop 1
    v_add_f32_dpp v20, v20, v20 row_shr:1 row_mask:0xf bank_mask:0xf bound_ctrl:0
    s_nop 1
    v_add_f32_dpp v20, v20, v20 row_shr:2 row_mask:0xf bank_mask:0xf bound_ctrl:0
    s_nop 1
    v_add_f32_dpp v20, v20, v20 row_shr:4 row_mask:0xf bank_mask:0xf bound_ctrl:0
    s_nop 1
    v_add_f32_dpp v20, v20, v20 row_shr:8 row_mask:0xf bank_mask:0xf bound_ctrl:0
    s_nop 1
    v_add_f32_dpp v20, v20, v20 row_bcast:15 row_mask:0xa bank_mask:0xf
    s_nop 1
    v_add_f32_dpp v20, v20, v20 row_bcast:31 row_mask:0xc bank_mask:0xf
    s_nop 0
    v_readlane_b32 s4, v20, 63
    s_nop 3
    v_writelane_b32 v16, s4, 11
    s_add_u32 s33, s22, 48
    s_mul_i32 s26, s34, 12
    s_add_u32 s26, s26, s33
    s_cmp_ge_u32 s26, 49
    s_cselect_b32 s35, 49, 0
    s_sub_u32 s26, s26, s35
    s_mul_i32 s27, s26, 147
    s_lshr_b32 s27, s27, 10
    s_mul_i32 s28, s27, 7
    s_sub_u32 s28, s26, s28
    s_mul_i32 s25, s27, 229376
    s_lshl_b32 s28, s28, 8
    s_add_u32 s25, s25, s28
    s_add_u32 s25, s25, s24
    s_add_u32 s25, s25, 128
    s_cmp_lt_u32 s33, 49
    s_cselect_b32 s25, s25, 0x40000000
    buffer_load_dword v42, v41, s[52:55], s25 offen
    v_lshlrev_b32 v20, 16, v112
    v_and_b32 v21, 0xffff0000, v112
    v_lshlrev_b32 v22, 16, v113
    v_and_b32 v23, 0xffff0000, v113
    v_lshlrev_b32 v24, 16, v114
    v_and_b32 v25, 0xffff0000, v114
    v_lshlrev_b32 v26, 16, v115
    v_and_b32 v27, 0xffff0000, v115
    v_mul_f32 v20, v20, v8
    v_mul_f32 v21, v21, v9
    v_mul_f32 v22, v22, v10
    v_mul_f32 v23, v23, v11
    v_mul_f32 v24, v24, v12
    v_mul_f32 v25, v25, v13
    v_mul_f32 v26, v26, v14
    v_mul_f32 v27, v27, v15
    v_cvt_pk_bf16_f32 v28, v20, v21
    v_cvt_pk_bf16_f32 v29, v22, v23
    v_cvt_pk_bf16_f32 v30, v24, v25
    v_cvt_pk_bf16_f32 v31, v26, v27
    v_lshlrev_b32 v20, 16, v28
    v_and_b32 v21, 0xffff0000, v28
    v_lshlrev_b32 v22, 16, v29
    v_and_b32 v23, 0xffff0000, v29
    v_lshlrev_b32 v24, 16, v30
    v_and_b32 v25, 0xffff0000, v30
    v_lshlrev_b32 v26, 16, v31
    v_and_b32 v27, 0xffff0000, v31
    v_add_f32 v20, v20, v21
    v_add_f32 v22, v22, v23
    v_add_f32 v24, v24, v25
    v_add_f32 v26, v26, v27
    v_add_f32 v20, v20, v22
    v_add_f32 v24, v24, v26
    v_add_f32 v20, v20, v24
    s_nop 1
    v_add_f32_dpp v20, v20, v20 row_shr:1 row_mask:0xf bank_mask:0xf bound_ctrl:0
    s_nop 1
    v_add_f32_dpp v20, v20, v20 row_shr:2 row_mask:0xf bank_mask:0xf bound_ctrl:0
    s_nop 1
    v_add_f32_dpp v20, v20, v20 row_shr:4 row_mask:0xf bank_mask:0xf bound_ctrl:0
    s_nop 1
    v_add_f32_dpp v20, v20, v20 row_shr:8 row_mask:0xf bank_mask:0xf bound_ctrl:0
    s_nop 1
    v_add_f32_dpp v20, v20, v20 row_bcast:15 row_mask:0xa bank_mask:0xf
    s_nop 1
    v_add_f32_dpp v20, v20, v20 row_bcast:31 row_mask:0xc bank_mask:0xf
    s_nop 0
    v_readlane_b32 s4, v20, 63
    s_nop 3
    v_writelane_b32 v16, s4, 12
    v_lshlrev_b32 v20, 16, v116
    v_and_b32 v21, 0xffff0000, v116
    v_lshlrev_b32 v22, 16, v117
    v_and_b32 v23, 0xffff0000, v117
    v_lshlrev_b32 v24, 16, v118
    v_and_b32 v25, 0xffff0000, v118
    v_lshlrev_b32 v26, 16, v119
    v_and_b32 v27, 0xffff0000, v119
    v_mul_f32 v20, v20, v8
    v_mul_f32 v21, v21, v9
    v_mul_f32 v22, v22, v10
    v_mul_f32 v23, v23, v11
    v_mul_f32 v24, v24, v12
    v_mul_f32 v25, v25, v13
    v_mul_f32 v26, v26, v14
    v_mul_f32 v27, v27, v15
    v_cvt_pk_bf16_f32 v28, v20, v21
    v_cvt_pk_bf16_f32 v29, v22, v23
    v_cvt_pk_bf16_f32 v30, v24, v25
    v_cvt_pk_bf16_f32 v31, v26, v27
    v_lshlrev_b32 v20, 16, v28
    v_and_b32 v21, 0xffff0000, v28
    v_lshlrev_b32 v22, 16, v29
    v_and_b32 v23, 0xffff0000, v29
    v_lshlrev_b32 v24, 16, v30
    v_and_b32 v25, 0xffff0000, v30
    v_lshlrev_b32 v26, 16, v31
    v_and_b32 v27, 0xffff0000, v31
    v_add_f32 v20, v20, v21
    v_add_f32 v22, v22, v23
    v_add_f32 v24, v24, v25
    v_add_f32 v26, v26, v27
    v_add_f32 v20, v20, v22
    v_add_f32 v24, v24, v26
    v_add_f32 v20, v20, v24
    s_nop 1
    v_add_f32_dpp v20, v20, v20 row_shr:1 row_mask:0xf bank_mask:0xf bound_ctrl:0
    s_nop 1
    v_add_f32_dpp v20, v20, v20 row_shr:2 row_mask:0xf bank_mask:0xf bound_ctrl:0
    s_nop 1
    v_add_f32_dpp v20, v20, v20 row_shr:4 row_mask:0xf bank_mask:0xf bound_ctrl:0
    s_nop 1
    v_add_f32_dpp v20, v20, v20 row_shr:8 row_mask:0xf bank_mask:0xf bound_ctrl:0
    s_nop 1
    v_add_f32_dpp v20, v20, v20 row_bcast:15 row_mask:0xa bank_mask:0xf
    s_nop 1
    v_add_f32_dpp v20, v20, v20 row_bcast:31 row_mask:0xc bank_mask:0xf
    s_nop 0
    v_readlane_b32 s4, v20, 63
    s_nop 3
    v_writelane_b32 v16, s4, 13
    s_add_u32 s33, s22, 0
    s_mul_i32 s26, s34, 12
    s_add_u32 s26, s26, s33
    s_cmp_ge_u32 s26, 49
    s_cselect_b32 s35, 49, 0
    s_sub_u32 s26, s26, s35
    s_mul_i32 s27, s26, 147
    s_lshr_b32 s27, s27, 10
    s_mul_i32 s28, s27, 7
    s_sub_u32 s28, s26, s28
    s_mul_i32 s25, s27, 114688
    s_lshl_b32 s28, s28, 13
    s_add_u32 s25, s25, s28
    s_add_u32 s25, s25, s31
    s_add_u32 s25, s25, 0
    s_cmp_lt_u32 s33, 49
    s_cselect_b32 s25, s25, 0x40000000
    buffer_load_dword v42, v40, s[64:67], s25 offen
    v_lshlrev_b32 v20, 16, v120
    v_and_b32 v21, 0xffff0000, v120
    v_lshlrev_b32 v22, 16, v121
    v_and_b32 v23, 0xffff0000, v121
    v_lshlrev_b32 v24, 16, v122
    v_and_b32 v25, 0xffff0000, v122
    v_lshlrev_b32 v26, 16, v123
    v_and_b32 v27, 0xffff0000, v123
    v_mul_f32 v20, v20, v8
    v_mul_f32 v21, v21, v9
    v_mul_f32 v22, v22, v10
    v_mul_f32 v23, v23, v11
    v_mul_f32 v24, v24, v12
    v_mul_f32 v25, v25, v13
    v_mul_f32 v26, v26, v14
    v_mul_f32 v27, v27, v15
    v_cvt_pk_bf16_f32 v28, v20, v21
    v_cvt_pk_bf16_f32 v29, v22, v23
    v_cvt_pk_bf16_f32 v30, v24, v25
    v_cvt_pk_bf16_f32 v31, v26, v27
    v_lshlrev_b32 v20, 16, v28
    v_and_b32 v21, 0xffff0000, v28
    v_lshlrev_b32 v22, 16, v29
    v_and_b32 v23, 0xffff0000, v29
    v_lshlrev_b32 v24, 16, v30
    v_and_b32 v25, 0xffff0000, v30
    v_lshlrev_b32 v26, 16, v31
    v_and_b32 v27, 0xffff0000, v31
    v_add_f32 v20, v20, v21
    v_add_f32 v22, v22, v23
    v_add_f32 v24, v24, v25
    v_add_f32 v26, v26, v27
    v_add_f32 v20, v20, v22
    v_add_f32 v24, v24, v26
    v_add_f32 v20, v20, v24
    s_nop 1
    v_add_f32_dpp v20, v20, v20 row_shr:1 row_mask:0xf bank_mask:0xf bound_ctrl:0
    s_nop 1
    v_add_f32_dpp v20, v20, v20 row_shr:2 row_mask:0xf bank_mask:0xf bound_ctrl:0
    s_nop 1
    v_add_f32_dpp v20, v20, v20 row_shr:4 row_mask:0xf bank_mask:0xf bound_ctrl:0
    s_nop 1
    v_add_f32_dpp v20, v20, v20 row_shr:8 row_mask:0xf bank_mask:0xf bound_ctrl:0
    s_nop 1
    v_add_f32_dpp v20, v20, v20 row_bcast:15 row_mask:0xa bank_mask:0xf
    s_nop 1
    v_add_f32_dpp v20, v20, v20 row_bcast:31 row_mask:0xc bank_mask:0xf
    s_nop 0
    v_readlane_b32 s4, v20, 63
    s_nop 3
    v_writelane_b32 v16, s4, 14
    v_lshlrev_b32 v20, 16, v124
    v_and_b32 v21, 0xffff0000, v124
    v_lshlrev_b32 v22, 16, v125
    v_and_b32 v23, 0xffff0000, v125
    v_lshlrev_b32 v24, 16, v126
    v_and_b32 v25, 0xffff0000, v126
    v_lshlrev_b32 v26, 16, v127
    v_and_b32 v27, 0xffff0000, v127
    v_mul_f32 v20, v20, v8
    v_mul_f32 v21, v21, v9
    v_mul_f32 v22, v22, v10
    v_mul_f32 v23, v23, v11
    v_mul_f32 v24, v24, v12
    v_mul_f32 v25, v25, v13
    v_mul_f32 v26, v26, v14
    v_mul_f32 v27, v27, v15
    v_cvt_pk_bf16_f32 v28, v20, v21
    v_cvt_pk_bf16_f32 v29, v22, v23
    v_cvt_pk_bf16_f32 v30, v24, v25
    v_cvt_pk_bf16_f32 v31, v26, v27
    v_lshlrev_b32 v20, 16, v28
    v_and_b32 v21, 0xffff0000, v28
    v_lshlrev_b32 v22, 16, v29
    v_and_b32 v23, 0xffff0000, v29
    v_lshlrev_b32 v24, 16, v30
    v_and_b32 v25, 0xffff0000, v30
    v_lshlrev_b32 v26, 16, v31
    v_and_b32 v27, 0xffff0000, v31
    v_add_f32 v20, v20, v21
    v_add_f32 v22, v22, v23
    v_add_f32 v24, v24, v25
    v_add_f32 v26, v26, v27
    v_add_f32 v20, v20, v22
    v_add_f32 v24, v24, v26
    v_add_f32 v20, v20, v24
    s_nop 1
    v_add_f32_dpp v20, v20, v20 row_shr:1 row_mask:0xf bank_mask:0xf bound_ctrl:0
    s_nop 1
    v_add_f32_dpp v20, v20, v20 row_shr:2 row_mask:0xf bank_mask:0xf bound_ctrl:0
    s_nop 1
    v_add_f32_dpp v20, v20, v20 row_shr:4 row_mask:0xf bank_mask:0xf bound_ctrl:0
    s_nop 1
    v_add_f32_dpp v20, v20, v20 row_shr:8 row_mask:0xf bank_mask:0xf bound_ctrl:0
    s_nop 1
    v_add_f32_dpp v20, v20, v20 row_bcast:15 row_mask:0xa bank_mask:0xf
    s_nop 1
    v_add_f32_dpp v20, v20, v20 row_bcast:31 row_mask:0xc bank_mask:0xf
    s_nop 0
    v_readlane_b32 s4, v20, 63
    s_nop 3
    v_writelane_b32 v16, s4, 15
    v_cvt_pk_bf16_f32 v16, v16, v16
    v_and_b32 v16, 0xffff0000, v16
    v_mul_f32 v16, 0xbfb8aa3b, v16
    v_exp_f32 v16, v16
    s_nop 0
    v_add_f32 v16, 1.0, v16
    v_rcp_f32 v16, v16
    s_mul_i32 s42, s42, 0x9e3779b1
    s_add_u32 s42, s42, 0x7f4a7c15
    v_cvt_pk_bf16_f32 v16, v16, v16
    v_and_b32 v16, 0xffff0000, v16
    v_mov_b32 v17, s42
    s_lshl_b32 s3, s97, 3
    s_add_u32 s3, s3, 4096
    v_lshl_add_u32 v2, v1, 3, s3
    v_cmp_gt_u32 vcc, 16, v1
    s_nop 1
    v_cndmask_b32 v2, v3, v2, vcc
    s_barrier
    buffer_store_dwordx2 v[16:17], v2, s[72:75], 0 offen sc1
    s_add_u32 s33, s22, 16
    s_mul_i32 s26, s34, 12
    s_add_u32 s26, s26, s33
    s_cmp_ge_u32 s26, 49
    s_cselect_b32 s35, 49, 0
    s_sub_u32 s26, s26, s35
    s_mul_i32 s27, s26, 147
    s_lshr_b32 s27, s27, 10
    s_mul_i32 s28, s27, 7
    s_sub_u32 s28, s26, s28
    s_mul_i32 s25, s27, 114688
    s_lshl_b32 s28, s28, 13
    s_add_u32 s25, s25, s28
    s_add_u32 s25, s25, s31
    s_add_u32 s25, s25, 0
    s_cmp_lt_u32 s33, 49
    s_cselect_b32 s25, s25, 0x40000000
    buffer_load_dword v42, v40, s[64:67], s25 offen
    s_add_u32 s33, s22, 32
    s_mul_i32 s26, s34, 12
    s_add_u32 s26, s26, s33
    s_cmp_ge_u32 s26, 49
    s_cselect_b32 s35, 49, 0
    s_sub_u32 s26, s26, s35
    s_mul_i32 s27, s26, 147
    s_lshr_b32 s27, s27, 10
    s_mul_i32 s28, s27, 7
    s_sub_u32 s28, s26, s28
    s_mul_i32 s25, s27, 114688
    s_lshl_b32 s28, s28, 13
    s_add_u32 s25, s25, s28
    s_add_u32 s25, s25, s31
    s_add_u32 s25, s25, 0
    s_cmp_lt_u32 s33, 49
    s_cselect_b32 s25, s25, 0x40000000
    buffer_load_dword v42, v40, s[64:67], s25 offen
    s_add_u32 s33, s22, 48
    s_mul_i32 s26, s34, 12
    s_add_u32 s26, s26, s33
    s_cmp_ge_u32 s26, 49
    s_cselect_b32 s35, 49, 0
    s_sub_u32 s26, s26, s35
    s_mul_i32 s27, s26, 147
    s_lshr_b32 s27, s27, 10
    s_mul_i32 s28, s27, 7
    s_sub_u32 s28, s26, s28
    s_mul_i32 s25, s27, 114688
    s_lshl_b32 s28, s28, 13
    s_add_u32 s25, s25, s28
    s_add_u32 s25, s25, s31
    s_add_u32 s25, s25, 0
    s_cmp_lt_u32 s33, 49
    s_cselect_b32 s25, s25, 0x40000000
    buffer_load_dword v42, v40, s[64:67], s25 offen
    s_add_u32 s33, s22, 0
    s_mul_i32 s26, s34, 7
    s_add_u32 s26, s26, s33
    s_cmp_ge_u32 s26, 28
    s_cselect_b32 s35, 28, 0
    s_sub_u32 s26, s26, s35
    s_lshr_b32 s27, s26, 2
    s_mul_i32 s25, s27, 57344
    s_and_b32 s28, s26, 3
    s_lshl_b32 s28, s28, 7
    s_add_u32 s25, s25, s28
    s_add_u32 s25, s25, s32
    s_cmp_lt_u32 s33, 28
    s_cselect_b32 s25, s25, 0x40000000
    buffer_load_dword v42, v43, s[8:11], s25 offen
    s_add_u32 s33, s22, 16
    s_mul_i32 s26, s34, 7
    s_add_u32 s26, s26, s33
    s_cmp_ge_u32 s26, 28
    s_cselect_b32 s35, 28, 0
    s_sub_u32 s26, s26, s35
    s_lshr_b32 s27, s26, 2
    s_mul_i32 s25, s27, 57344
    s_and_b32 s28, s26, 3
    s_lshl_b32 s28, s28, 7
    s_add_u32 s25, s25, s28
    s_add_u32 s25, s25, s32
    s_cmp_lt_u32 s33, 28
    s_cselect_b32 s25, s25, 0x40000000
    buffer_load_dword v42, v43, s[8:11], s25 offen
    s_add_u32 s33, s22, 0
    s_mul_i32 s26, s34, 7
    s_add_u32 s26, s26, s33
    s_cmp_ge_u32 s26, 28
    s_cselect_b32 s35, 28, 0
    s_sub_u32 s26, s26, s35
    s_lshr_b32 s27, s26, 2
    s_mul_i32 s25, s27, 57344
    s_and_b32 s28, s26, 3
    s_lshl_b32 s28, s28, 7
    s_add_u32 s25, s25, s28
    s_add_u32 s25, s25, s32
    s_cmp_lt_u32 s33, 28
    s_cselect_b32 s25, s25, 0x40000000
    buffer_load_dword v42, v43, s[12:15], s25 offen
    s_add_u32 s33, s22, 16
    s_mul_i32 s26, s34, 7
    s_add_u32 s26, s26, s33
    s_cmp_ge_u32 s26, 28
    s_cselect_b32 s35, 28, 0
    s_sub_u32 s26, s26, s35
    s_lshr_b32 s27, s26, 2
    s_mul_i32 s25, s27, 57344
    s_and_b32 s28, s26, 3
    s_lshl_b32 s28, s28, 7
    s_add_u32 s25, s25, s28
    s_add_u32 s25, s25, s32
    s_cmp_lt_u32 s33, 28
    s_cselect_b32 s25, s25, 0x40000000
    buffer_load_dword v42, v43, s[12:15], s25 offen
    s_add_u32 s33, s22, 0
    s_mul_i32 s26, s34, 12
    s_add_u32 s26, s26, s33
    s_cmp_ge_u32 s26, 49
    s_cselect_b32 s35, 49, 0
    s_sub_u32 s26, s26, s35
    s_mul_i32 s27, s26, 147
    s_lshr_b32 s27, s27, 10
    s_mul_i32 s28, s27, 7
    s_sub_u32 s28, s26, s28
    s_mul_i32 s25, s27, 114688
    s_lshl_b32 s28, s28, 13
    s_add_u32 s25, s25, s28
    s_add_u32 s25, s25, s31
    s_add_u32 s25, s25, 57344
    s_cmp_lt_u32 s33, 49
    s_cselect_b32 s25, s25, 0x40000000
    buffer_load_dword v42, v40, s[64:67], s25 offen
    s_add_u32 s33, s22, 16
    s_mul_i32 s26, s34, 12
    s_add_u32 s26, s26, s33
    s_cmp_ge_u32 s26, 49
    s_cselect_b32 s35, 49, 0
    s_sub_u32 s26, s26, s35
    s_mul_i32 s27, s26, 147
    s_lshr_b32 s27, s27, 10
    s_mul_i32 s28, s27, 7
    s_sub_u32 s28, s26, s28
    s_mul_i32 s25, s27, 114688
    s_lshl_b32 s28, s28, 13
    s_add_u32 s25, s25, s28
    s_add_u32 s25, s25, s31
    s_add_u32 s25, s25, 57344
    s_cmp_lt_u32 s33, 49
    s_cselect_b32 s25, s25, 0x40000000
    buffer_load_dword v42, v40, s[64:67], s25 offen
    s_add_u32 s33, s22, 32
    s_mul_i32 s26, s34, 12
    s_add_u32 s26, s26, s33
    s_cmp_ge_u32 s26, 49
    s_cselect_b32 s35, 49, 0
    s_sub_u32 s26, s26, s35
    s_mul_i32 s27, s26, 147
    s_lshr_b32 s27, s27, 10
    s_mul_i32 s28, s27, 7
    s_sub_u32 s28, s26, s28
    s_mul_i32 s25, s27, 114688
    s_lshl_b32 s28, s28, 13
    s_add_u32 s25, s25, s28
    s_add_u32 s25, s25, s31
    s_add_u32 s25, s25, 57344
    s_cmp_lt_u32 s33, 49
    s_cselect_b32 s25, s25, 0x40000000
    buffer_load_dword v42, v40, s[64:67], s25 offen
    s_add_u32 s33, s22, 48
    s_mul_i32 s26, s34, 12
    s_add_u32 s26, s26, s33
    s_cmp_ge_u32 s26, 49
    s_cselect_b32 s35, 49, 0
    s_sub_u32 s26, s26, s35
    s_mul_i32 s27, s26, 147
    s_lshr_b32 s27, s27, 10
    s_mul_i32 s28, s27, 7
    s_sub_u32 s28, s26, s28
    s_mul_i32 s25, s27, 114688
    s_lshl_b32 s28, s28, 13
    s_add_u32 s25, s25, s28
    s_add_u32 s25, s25, s31
    s_add_u32 s25, s25, 57344
    s_cmp_lt_u32 s33, 49
    s_cselect_b32 s25, s25, 0x40000000
    buffer_load_dword v42, v40, s[64:67], s25 offen
    s_cmp_lg_u32 s2, 224
    s_cbranch_scc1 L_HEND
    s_cmp_lg_u32 s43, 0
    s_cbranch_scc1 L_HEND
    v_min_u32 v4, 27, v1
    v_lshlrev_b32 v4, 9, v4
    v_add_u32 v4, 856448, v4
    v_and_b32 v5, 31, v1
    v_lshlrev_b32 v5, 9, v5
    v_add_u32 v5, 4100, v5
L_HPOLL:
    s_cmp_eq_u32 s96, 0
    s_cbranch_scc1 L_HEND
    s_sub_u32 s96, s96, 1
    s_sleep 8
    buffer_load_dword v6, v4, s[72:75], 0 offen sc1
    buffer_load_dword v7, v5, s[72:75], 0 offen sc1
    s_waitcnt vmcnt(1)
    v_xor_b32 v6, v6, v17
    s_waitcnt vmcnt(0)
    v_xor_b32 v7, v7, v17
    v_or_b32 v6, v6, v7
    v_cmp_ne_u32 vcc, 0, v6
    s_nop 1
    s_cbranch_vccnz L_HPOLL
    v_cmp_eq_u32 vcc, 0, v1
    v_mov_b32 v4, 0
    s_nop 0
    v_cndmask_b32 v4, v3, v4, vcc
    buffer_store_dword v17, v4, s[72:75], 0 offen sc1
L_HEND:
    s_endpgm
L_CODE_END:
.section .rodata,"a"
.p2align 6
.amdhsa_kernel gated_mix__ssm_conv_s5__glu_gated_glu__prompt_kernel
  .amdhsa_next_free_vgpr 512
  .amdhsa_next_free_sgpr 102
  .amdhsa_accum_offset 256
  .amdhsa_group_segment_fixed_size 0
  .amdhsa_kernarg_size 136
  .amdhsa_user_sgpr_count 2
  .amdhsa_user_sgpr_kernarg_segment_ptr 1
  .amdhsa_system_sgpr_workgroup_id_x 1
.end_amdhsa_kernel
```
